```python
import torch

def _softmax(x, axis=-1):
    return torch.softmax(x, dim=axis)
def _gelu(x):
    return torch.nn.functional.gelu(x, approximate="tanh")
def _silu(x):
    return torch.nn.functional.silu(x)
def _sigmoid(x):
    return torch.sigmoid(x)
def _layernorm(x, axis=-1, eps=1e-5):
    m = x.mean(dim=axis, keepdim=True)
    v = x.var(dim=axis, keepdim=True, unbiased=False)
    return (x - m) / torch.sqrt(v + eps)
def _scatter_add(tgt, idx, src, axis=0):
    return tgt.clone().index_add_(axis, idx, src)
def _segment_sum(src, seg, n):
    out = torch.zeros((n,) + src.shape[1:], dtype=src.dtype)
    return out.index_add_(0, seg, src)
def _pad(x, pw):
    flat = tuple(v for pair in reversed(pw) for v in pair)
    return torch.nn.functional.pad(x, flat)

kernel_name = 'sequential_preLN__ssm_conv_h3__mixer_token_mlp__prompt'

def setup_inputs():

    _w = (lambda a: (lambda t: t.to(torch.bfloat16) if t.is_floating_point() else t)(torch.as_tensor(a)))
    def _A_setup():
        B, S, D = 1, 2048, 448
        ks = 4
        return {
            "q": _w((lambda *s: torch.randn(*s, dtype=torch.bfloat16) * 0.05)(B, S, D)),
            "k": _w((lambda *s: torch.randn(*s, dtype=torch.bfloat16) * 0.2)(B, S, D)),
            "v": _w((lambda *s: torch.randn(*s, dtype=torch.bfloat16) * 0.2)(B, S, D)),
            "shift_k": _w((lambda *s: torch.randn(*s, dtype=torch.bfloat16) * 0.2)(D, ks) * 0.5),
            "ssm_k": _w((lambda *s: torch.randn(*s, dtype=torch.bfloat16) * 0.4)(D, S) * (1.0 / S ** 0.5)),
            "ssm_D": _w((lambda *s: torch.randn(*s, dtype=torch.bfloat16) * 0.2)(D)),
        }
    _A_in = _A_setup()

    def _B_setup():
        B, S, D, F = 1, 2048, 448, 1792
        return {
            "x": _w((lambda *s: torch.randn(*s, dtype=torch.bfloat16) * 0.05)(B, S, D)),
            "w1": _w((lambda *s: torch.randn(*s, dtype=torch.bfloat16) * 0.4)(S, F) * (S ** -0.5)),
            "b1": _w((lambda *s: torch.randn(*s, dtype=torch.bfloat16) * 3.2)(F) * 0.02),
            "w2": _w((lambda *s: torch.randn(*s, dtype=torch.bfloat16) * 0.2)(F, S) * (F ** -0.5)),
            "b2": _w((lambda *s: torch.randn(*s, dtype=torch.bfloat16) * 0.4)(S) * 0.02),
        }
    _B_in = _B_setup()

    return {
        "A_q": _A_in["q"],
        "A_k": _A_in["k"],
        "A_v": _A_in["v"],
        "A_shift_k": _A_in["shift_k"],
        "A_ssm_k": _A_in["ssm_k"],
        "A_ssm_D": _A_in["ssm_D"],
        "B_x": _B_in["x"],
        "B_w1": _B_in["w1"],
        "B_b1": _B_in["b1"],
        "B_w2": _B_in["w2"],
        "B_b2": _B_in["b2"],
    }

def reference(A_q, A_k, A_v, A_shift_k, A_ssm_k, A_ssm_D, B_x, B_w1, B_b1, B_w2, B_b2):
    def _A_ref(q, k, v, shift_k, ssm_k, ssm_D):
        B, S, D = q.shape
        ks = shift_k.shape[-1]
        k_pad = _pad(k, ((0, 0), (ks - 1, 0), (0, 0)))
        k_shift = torch.zeros_like(k)
        for t in range(ks):
            k_shift = k_shift + k_pad[:, t:t + S, :] * shift_k[:, ks - 1 - t][None, None, :]
        kv = k_shift * v
        L = 2 * S
        kv_pad = _pad(kv, ((0, 0), (0, S), (0, 0)))
        kf_pad = _pad(ssm_k, ((0, 0), (0, S)))
        kv_f = (lambda x, axes=(-2,-1): torch.fft.rfft2(x.float(), dim=axes))(kv_pad[:, None, :, :], axes=(1, 2))
        kf_f = (lambda x, axes=(-2,-1): torch.fft.rfft2(x.float(), dim=axes))(kf_pad[:, None, :], axes=(1, 2))
        kf_f = (lambda x, *d: x.permute(*d))(kf_f, 1, 2, 0)
        y_f = kv_f * kf_f[None, :, :, :]
        y = (lambda x, s, axes=(-2,-1): torch.fft.irfft2(x, s=s, dim=axes).to(torch.bfloat16))(y_f, (1, L), axes=(1, 2))[:, 0, :S, :]
        y = y + kv * ssm_D[None, None, :]
        return q * y

    def _B_ref(x, w1, b1, w2, b2):
        B, S, D = x.shape
        h = _layernorm(x, axis=-1)
        u = torch.einsum("bsd,sf->bdf", h, w1) + b1
        u = _gelu(u)
        y = torch.einsum("bdf,fs->bds", u, w2) + b2
        return (lambda x, *d: x.permute(*d))(y, 0, 2, 1)

    x = A_q
    h = x + _A_ref(_layernorm(x, axis=-1), A_k, A_v, A_shift_k, A_ssm_k, A_ssm_D)
    h2 = h + _B_ref(_layernorm(h, axis=-1), B_w1, B_b1, B_w2, B_b2)
    return h2
```

```asm
; @launch grid=(256,1,1) block=(256,1,1) lds=163840
.amdgcn_target "amdgcn-amd-amdhsa--gfx950"
.text
.globl sequential_preLN__ssm_conv_h3__mixer_token_mlp__prompt_kernel
.p2align 8
.type sequential_preLN__ssm_conv_h3__mixer_token_mlp__prompt_kernel,@function
sequential_preLN__ssm_conv_h3__mixer_token_mlp__prompt_kernel:
    s_cmp_ge_u32 s2, 256
    s_cbranch_scc1 END
    s_load_dwordx8 s[4:11], s[0:1], 0
    s_load_dwordx4 s[12:15], s[0:1], 32
    s_load_dwordx16 s[36:51], s[0:1], 48
    s_getpc_b64 s[82:83]
L_PC:
    v_lshrrev_b32 v1, 6, v0
    s_lshr_b32 s80, s2, 3
    s_lshl_b32 s80, s80, 2
    v_add_u32 v1, s80, v1
    v_and_b32 v2, 63, v0
    v_lshl_add_u32 v1, v2, 7, v1
    v_lshlrev_b32 v1, 7, v1
    s_mov_b32 s80, L_CODE_END-L_PC-4
    v_min_u32 v1, s80, v1
    v_cmp_gt_u32 vcc, 3, v2
    s_and_saveexec_b64 s[80:81], vcc
    global_load_dword v248, v1, s[82:83]
    s_mov_b64 exec, s[80:81]
    v_mov_b32 v249, 0x80000000
    v_lshrrev_b32 v1, 6, v0
    s_lshr_b32 s86, s2, 5
    s_and_b32 s87, s2, 31
    v_readfirstlane_b32 s52, v1
    v_lshrrev_b32 v3, 5, v0
    v_and_b32 v4, 31, v0
    s_mul_i32 s62, s87, 57344
    s_lshl_b32 s63, s86, 7
    s_add_u32 s62, s62, s63
    v_mul_u32_u24 v128, 7168, v3
    v_lshl_add_u32 v128, v4, 2, v128
    v_add_u32 v128, s62, v128
    v_subrev_u32 v129, 2688, v128
    v_cmp_gt_u32 vcc, 2688, v128
    s_nop 1
    v_cndmask_b32 v129, v129, v249, vcc
    s_lshl_b32 s62, s86, 9
    v_lshl_add_u32 v149, v4, 4, s62
    s_mul_i32 s62, s86, 262144
    s_lshl_b32 s63, s87, 7
    s_add_u32 s62, s62, s63
    v_lshrrev_b32 v5, 3, v0
    v_mul_u32_u24 v150, 4096, v5
    v_and_b32 v6, 7, v0
    v_lshl_add_u32 v150, v6, 4, v150
    v_add_u32 v150, s62, v150
    s_mul_i32 s62, s2, 8192
    v_lshl_add_u32 v230, v0, 4, s62
    s_waitcnt lgkmcnt(0)
    s_mov_b32 s16, s50
    s_and_b32 s17, s51, 0xffff
    s_mov_b32 s18, 0x1000000
    s_mov_b32 s19, 0x20000
    s_mov_b32 s62, 0x8000
    buffer_load_dword v151, off, s[16:19], s62 sc1
    s_cmp_ge_u32 s2, 224
    s_cbranch_scc1 CPATH
    s_mov_b32 s28, s6
    s_and_b32 s29, s7, 0xffff
    s_mov_b32 s30, 0x1c0000
    s_mov_b32 s31, 0x20000
    s_mov_b32 s32, s8
    s_and_b32 s33, s9, 0xffff
    s_mov_b32 s34, 0x1c0000
    s_mov_b32 s35, 0x20000
    s_mov_b32 s64, s10
    s_and_b32 s65, s11, 0xffff
    s_mov_b32 s66, 0xe00
    s_mov_b32 s67, 0x20000
    v_mov_b32 v4, -1
    v_mov_b32 v5, -1
    v_mov_b32 v6, -1
    v_mov_b32 v7, -1
    s_mov_b32 s83, 0x100000
    buffer_store_dwordx4 v[4:7], v150, s[16:19], s83 offen sc1
    s_mov_b32 s82, 0x120000
    buffer_store_dwordx4 v[4:7], v150, s[16:19], s82 offen sc1
    s_movk_i32 s81, 4480
    buffer_load_dwordx4 v[152:155], v149, s[64:67], 0 offen
    buffer_load_dword v130, v129, s[28:31], 0 offen offset:0 nt
    buffer_load_dword v131, v129, s[28:31], 0 offen offset:896 nt
    buffer_load_dword v132, v129, s[28:31], 0 offen offset:1792 nt
    buffer_load_dword v133, v128, s[28:31], 0 offen offset:0 nt
    buffer_load_dword v134, v128, s[28:31], 0 offen offset:896 nt
    buffer_load_dword v135, v128, s[28:31], 0 offen offset:1792 nt
    buffer_load_dword v136, v128, s[28:31], 0 offen offset:2688 nt
    buffer_load_dword v137, v128, s[28:31], 0 offen offset:3584 nt
    buffer_load_dword v138, v128, s[28:31], s81 offen offset:0 nt
    buffer_load_dword v139, v128, s[28:31], s81 offen offset:896 nt
    buffer_load_dword v140, v128, s[28:31], s81 offen offset:1792 nt
    buffer_load_dword v141, v128, s[32:35], 0 offen offset:0 nt
    buffer_load_dword v142, v128, s[32:35], 0 offen offset:896 nt
    buffer_load_dword v143, v128, s[32:35], 0 offen offset:1792 nt
    buffer_load_dword v144, v128, s[32:35], 0 offen offset:2688 nt
    buffer_load_dword v145, v128, s[32:35], 0 offen offset:3584 nt
    buffer_load_dword v146, v128, s[32:35], s81 offen offset:0 nt
    buffer_load_dword v147, v128, s[32:35], s81 offen offset:896 nt
    buffer_load_dword v148, v128, s[32:35], s81 offen offset:1792 nt
    s_and_b32 s53, s2, 7
    s_lshr_b32 s54, s2, 3
    s_lshl_b32 s55, s53, 5
    s_add_u32 s55, s55, s54
    s_mul_i32 s57, s54, 9363
    s_lshr_b32 s57, s57, 16
    s_mul_i32 s58, s57, 7
    s_sub_u32 s58, s54, s58
    s_mul_i32 s62, s53, 3
    s_min_u32 s81, s53, 4
    s_add_u32 s62, s62, s81
    s_add_u32 s57, s57, s62
    s_mul_i32 s56, s57, 7
    s_add_u32 s56, s56, s58
    s_cmp_lt_u32 s53, 4
    s_cselect_b32 s62, 28, 21
    s_cmp_lt_u32 s54, s62
    s_cselect_b32 s95, 0, 0x80000000
    s_mul_i32 s59, s54, 9363
    s_lshr_b32 s59, s59, 16
    s_mul_i32 s60, s59, 7
    s_sub_u32 s60, s54, s60
    s_lshl_b32 s62, s53, 2
    s_add_u32 s59, s62, s59
    s_and_b32 s62, s57, 3
    s_mul_i32 s62, s62, 0
    s_mul_i32 s63, s58, 5
    s_add_u32 s62, s62, s63
    s_and_b32 s90, s62, 31
    s_and_b32 s62, s59, 3
    s_mul_i32 s62, s62, 0
    s_lshl_b32 s63, s60, 2
    s_add_u32 s62, s62, s63
    s_cmp_ge_u32 s62, 28
    s_cselect_b32 s63, 28, 0
    s_sub_u32 s91, s62, s63
    s_lshl_b32 s62, s58, 5
    s_add_u32 s62, s62, 3
    s_mul_i32 s62, s62, 9363
    s_lshr_b32 s90, s62, 16
    s_mov_b32 s91, 0
    s_mul_i32 s92, s90, 57344
    s_sub_u32 s92, s92, 57344
    s_mul_i32 s93, s91, 65536
    s_sub_u32 s93, s93, 65536
    s_mov_b32 s72, s12
    s_and_b32 s73, s13, 0xffff
    s_mov_b32 s74, 0x1c0000
    s_mov_b32 s75, 0x20000
    v_lshrrev_b32 v2, 7, v0
    v_and_b32 v3, 127, v0
    s_lshl_b32 s62, s2, 13
    v_lshlrev_b32 v4, 12, v2
    v_add_u32 v4, s62, v4
    v_lshl_add_u32 v108, v3, 4, v4
    s_lshl_b32 s63, s2, 1
    v_add_u32 v5, s63, v2
    v_mul_u32_u24 v5, 4096, v5
    v_lshl_add_u32 v245, v3, 4, v5
    v_subrev_u32 v88, 32, v108
    v_cmp_gt_u32 vcc, 2, v3
    s_nop 1
    v_cndmask_b32 v88, v88, v249, vcc
    v_add_u32 v91, 4064, v108
    v_cndmask_b32 v91, v249, v91, vcc
    v_subrev_u32 v89, 16, v108
    v_cmp_gt_u32 vcc, 1, v3
    s_nop 1
    v_cndmask_b32 v89, v89, v249, vcc
    v_add_u32 v92, 4080, v108
    v_cndmask_b32 v92, v249, v92, vcc
    v_add_u32 v90, 2016, v108
    buffer_load_dwordx4 v[64:67], v88, s[72:75], 0 offen nt
    buffer_load_dwordx2 v[68:69], v89, s[72:75], 0 offen nt
    buffer_load_dwordx4 v[72:75], v90, s[72:75], 0 offen nt
    buffer_load_dwordx2 v[76:77], v90, s[72:75], 0 offen offset:16 nt
    buffer_load_dwordx4 v[80:83], v91, s[72:75], 0 offen nt
    buffer_load_dwordx2 v[84:85], v92, s[72:75], 0 offen nt
    s_lshl_b32 s63, s2, 2
    s_load_dword s88, s[14:15], s63
    v_and_b32 v1, 63, v0
    v_lshrrev_b32 v2, 1, v1
    v_and_b32 v3, 1, v1
    v_lshl_add_u32 v4, v3, 5, v2
    s_lshl_b32 s62, s52, 6
    v_add_u32 v4, s62, v4
    s_mul_i32 s63, s55, 7168
    v_lshl_add_u32 v5, v4, 2, s63
    v_cmp_gt_u32 vcc, 224, v4
    s_nop 1
    v_cndmask_b32 v37, v249, v5, vcc
    v_add_u32 v2, s62, v2
    v_mul_u32_u24 v2, 8192, v2
    v_lshl_add_u32 v2, v3, 4, v2
    s_lshl_b32 s81, s55, 5
    v_add_u32 v36, s81, v2
    s_cmp_lt_u32 s52, 3
    s_mov_b32 s81, 262144
    s_cselect_b32 s81, s81, 0x80000000
    v_add_u32 v241, s81, v36
    s_lshr_b32 s63, s55, 6
    s_mul_i32 s63, s63, 65536
    s_bfe_u32 s81, s55, 0x50001
    s_lshl_b32 s81, s81, 11
    s_add_u32 s63, s63, s81
    s_and_b32 s81, s55, 1
    s_lshl_b32 s81, s81, 9
    s_add_u32 s63, s63, s81
    s_mul_i32 s81, s52, 524288
    s_add_u32 s63, s63, s81
    v_lshrrev_b32 v2, 5, v1
    v_lshlrev_b32 v2, 10, v2
    v_and_b32 v3, 31, v1
    v_lshl_add_u32 v2, v3, 4, v2
    v_add_u32 v38, s63, v2
    s_cmp_lt_u32 s52, 3
    s_mov_b32 s81, 262144
    s_cselect_b32 s81, s81, 0x80000000
    v_add_u32 v242, s81, v38
    v_bfe_u32 v2, v0, 4, 1
    v_lshlrev_b32 v2, 5, v2
    v_bfe_u32 v3, v0, 5, 1
    v_lshl_add_u32 v2, v3, 4, v2
    s_lshl_b32 s81, s52, 2
    v_add_u32 v243, s81, v2
    v_and_b32 v2, 7, v0
    v_lshlrev_b32 v244, 5, v2
    s_mov_b32 s20, s38
    s_and_b32 s21, s39, 0xffff
    s_mov_b32 s22, 0x700000
    s_mov_b32 s23, 0x20000
    s_mov_b32 s24, s42
    s_and_b32 s25, s43, 0xffff
    s_mov_b32 s26, 0x700000
    s_mov_b32 s27, 0x20000
    s_lshl_b32 s61, s52, 11
    s_add_u32 s61, s61, 49152
    v_and_b32 v1, 63, v0
    v_lshrrev_b32 v2, 3, v1
    v_and_b32 v3, 7, v1
    v_bfe_u32 v4, v1, 4, 1
    v_lshlrev_b32 v4, 2, v4
    v_xor_b32 v3, v3, v4
    v_lshlrev_b32 v3, 4, v3
    s_mul_i32 s62, s52, 1835008
    s_lshl_b32 s63, s57, 7
    s_add_u32 s62, s62, s63
    s_or_b32 s62, s62, s95
    v_mul_u32_u24 v4, 3584, v2
    v_add_u32 v4, v4, v3
    v_add_u32 v24, s62, v4
    v_add_u32 v25, 27648, v24
    s_mul_i32 s62, s52, 1835008
    s_lshl_b32 s63, s59, 7
    s_add_u32 s62, s62, s63
    v_lshlrev_b32 v4, 12, v2
    v_add_u32 v4, v4, v3
    v_add_u32 v26, s62, v4
    v_add_u32 v27, 31744, v26
    v_lshrrev_b32 v5, 5, v1
    v_bfe_u32 v6, v1, 2, 2
    v_lshlrev_b32 v7, 7, v6
    v_lshl_add_u32 v7, v5, 10, v7
    v_bfe_u32 v2, v1, 4, 1
    v_bfe_u32 v3, v1, 1, 1
    v_lshl_add_u32 v2, v2, 1, v3
    v_lshrrev_b32 v6, 1, v6
    v_lshlrev_b32 v6, 2, v6
    v_xor_b32 v2, v2, v6
    v_lshl_add_u32 v7, v2, 4, v7
    v_and_b32 v3, 1, v1
    v_lshl_add_u32 v7, v3, 3, v7
    s_and_b32 s62, s52, 1
    s_lshl_b32 s62, s62, 6
    v_xor_b32 v7, s62, v7
    v_add_u32 v28, s61, v7
    v_xor_b32 v29, 64, v28
    v_add_u32 v30, 57344, v28
    v_add_u32 v31, 57344, v29
    v_lshlrev_b32 v4, 4, v1
    s_lshr_b32 s63, s52, 1
    s_lshl_b32 s63, s63, 10
    s_mul_i32 s62, s52, 65536
    s_add_u32 s62, s62, s63
    s_mul_i32 s81, s58, 262144
    s_add_u32 s62, s62, s81
    s_or_b32 s62, s62, s95
    v_add_u32 v32, s62, v4
    v_xor_b32 v33, 1024, v32
    s_mul_i32 s62, s52, 57344
    s_add_u32 s62, s62, s63
    s_mul_i32 s81, s60, 229376
    s_add_u32 s62, s62, s81
    v_add_u32 v34, s62, v4
    v_xor_b32 v35, 1024, v34
    s_lshl_b32 s62, s57, 2
    s_and_b32 s81, s52, 1
    s_lshl_b32 s81, s81, 1
    s_add_u32 s62, s62, s81
    s_mul_i32 s81, s62, 2341
    s_lshr_b32 s81, s81, 16
    s_mul_i32 s80, s81, 28
    s_sub_u32 s62, s62, s80
    s_lshl_b32 s62, s62, 11
    s_mul_i32 s81, s81, 57344
    s_add_u32 s62, s62, s81
    s_mul_i32 s81, s58, 229376
    s_add_u32 s62, s62, s81
    s_add_u32 s62, s62, s63
    s_or_b32 s62, s62, s95
    v_add_u32 v39, s62, v4
    v_lshrrev_b32 v3, 5, v0
    v_and_b32 v4, 31, v0
    v_and_b32 v5, 7, v4
    v_xor_b32 v5, v5, v3
    v_lshlrev_b32 v5, 4, v5
    v_lshl_add_u32 v5, v4, 8, v5
    v_add_u32 v228, 155648, v5
    v_lshrrev_b32 v3, 3, v0
    v_and_b32 v4, 7, v0
    v_bfe_u32 v5, v0, 4, 3
    v_xor_b32 v4, v4, v5
    v_lshlrev_b32 v4, 4, v4
    v_lshl_add_u32 v4, v3, 7, v4
    v_add_u32 v229, 155648, v4
    s_waitcnt vmcnt(26)
    v_readfirstlane_b32 s3, v151
    s_add_u32 s3, s3, 0x9e3779b9
    s_barrier
    s_cmp_lg_u32 s52, 0
    s_cbranch_scc1 PUB_1
    s_lshl_b32 s62, s2, 7
    v_mov_b32 v2, s3
    s_mov_b64 exec, 1
    buffer_store_dword v2, off, s[16:19], s62 offset:0 sc1
    s_mov_b64 exec, -1
PUB_1:
    s_waitcnt vmcnt(25)
    v_lshlrev_b32 v156, 16, v152
    v_lshlrev_b32 v157, 16, v154
    v_and_b32 v158, 0xffff0000, v152
    v_and_b32 v159, 0xffff0000, v154
    v_lshlrev_b32 v160, 16, v153
    v_lshlrev_b32 v161, 16, v155
    v_and_b32 v162, 0xffff0000, v153
    v_and_b32 v163, 0xffff0000, v155
    s_waitcnt vmcnt(14)
    v_lshlrev_b32 v164, 16, v130
    v_and_b32 v165, 0xffff0000, v130
    v_lshlrev_b32 v166, 16, v131
    v_and_b32 v167, 0xffff0000, v131
    v_lshlrev_b32 v168, 16, v132
    v_and_b32 v169, 0xffff0000, v132
    v_lshlrev_b32 v170, 16, v133
    v_and_b32 v171, 0xffff0000, v133
    v_lshlrev_b32 v172, 16, v134
    v_and_b32 v173, 0xffff0000, v134
    v_lshlrev_b32 v174, 16, v135
    v_and_b32 v175, 0xffff0000, v135
    v_lshlrev_b32 v176, 16, v136
    v_and_b32 v177, 0xffff0000, v136
    v_lshlrev_b32 v178, 16, v137
    v_and_b32 v179, 0xffff0000, v137
    v_lshlrev_b32 v180, 16, v138
    v_and_b32 v181, 0xffff0000, v138
    v_lshlrev_b32 v182, 16, v139
    v_and_b32 v183, 0xffff0000, v139
    v_lshlrev_b32 v184, 16, v140
    v_and_b32 v185, 0xffff0000, v140
    v_pk_mul_f32 v[202:203], v[170:171], v[156:157]
    v_pk_mul_f32 v[204:205], v[172:173], v[156:157]
    v_pk_mul_f32 v[206:207], v[174:175], v[156:157]
    v_pk_mul_f32 v[208:209], v[176:177], v[156:157]
    v_pk_mul_f32 v[210:211], v[178:179], v[156:157]
    v_pk_mul_f32 v[212:213], v[180:181], v[156:157]
    v_pk_mul_f32 v[214:215], v[182:183], v[156:157]
    v_pk_mul_f32 v[216:217], v[184:185], v[156:157]
    v_pk_fma_f32 v[202:203], v[168:169], v[158:159], v[202:203]
    v_pk_fma_f32 v[204:205], v[170:171], v[158:159], v[204:205]
    v_pk_fma_f32 v[206:207], v[172:173], v[158:159], v[206:207]
    v_pk_fma_f32 v[208:209], v[174:175], v[158:159], v[208:209]
    v_pk_fma_f32 v[210:211], v[176:177], v[158:159], v[210:211]
    v_pk_fma_f32 v[212:213], v[178:179], v[158:159], v[212:213]
    v_pk_fma_f32 v[214:215], v[180:181], v[158:159], v[214:215]
    v_pk_fma_f32 v[216:217], v[182:183], v[158:159], v[216:217]
    v_pk_fma_f32 v[202:203], v[166:167], v[160:161], v[202:203]
    v_pk_fma_f32 v[204:205], v[168:169], v[160:161], v[204:205]
    v_pk_fma_f32 v[206:207], v[170:171], v[160:161], v[206:207]
    v_pk_fma_f32 v[208:209], v[172:173], v[160:161], v[208:209]
    v_pk_fma_f32 v[210:211], v[174:175], v[160:161], v[210:211]
    v_pk_fma_f32 v[212:213], v[176:177], v[160:161], v[212:213]
    v_pk_fma_f32 v[214:215], v[178:179], v[160:161], v[214:215]
    v_pk_fma_f32 v[216:217], v[180:181], v[160:161], v[216:217]
    v_pk_fma_f32 v[202:203], v[164:165], v[162:163], v[202:203]
    v_pk_fma_f32 v[204:205], v[166:167], v[162:163], v[204:205]
    v_pk_fma_f32 v[206:207], v[168:169], v[162:163], v[206:207]
    v_pk_fma_f32 v[208:209], v[170:171], v[162:163], v[208:209]
    v_pk_fma_f32 v[210:211], v[172:173], v[162:163], v[210:211]
    v_pk_fma_f32 v[212:213], v[174:175], v[162:163], v[212:213]
    v_pk_fma_f32 v[214:215], v[176:177], v[162:163], v[214:215]
    v_pk_fma_f32 v[216:217], v[178:179], v[162:163], v[216:217]
    s_waitcnt vmcnt(6)
    v_lshlrev_b32 v186, 16, v141
    v_and_b32 v187, 0xffff0000, v141
    v_lshlrev_b32 v188, 16, v142
    v_and_b32 v189, 0xffff0000, v142
    v_lshlrev_b32 v190, 16, v143
    v_and_b32 v191, 0xffff0000, v143
    v_lshlrev_b32 v192, 16, v144
    v_and_b32 v193, 0xffff0000, v144
    v_lshlrev_b32 v194, 16, v145
    v_and_b32 v195, 0xffff0000, v145
    v_lshlrev_b32 v196, 16, v146
    v_and_b32 v197, 0xffff0000, v146
    v_lshlrev_b32 v198, 16, v147
    v_and_b32 v199, 0xffff0000, v147
    v_lshlrev_b32 v200, 16, v148
    v_and_b32 v201, 0xffff0000, v148
    v_pk_mul_f32 v[202:203], v[202:203], v[186:187]
    v_pk_mul_f32 v[204:205], v[204:205], v[188:189]
    v_pk_mul_f32 v[206:207], v[206:207], v[190:191]
    v_pk_mul_f32 v[208:209], v[208:209], v[192:193]
    v_pk_mul_f32 v[210:211], v[210:211], v[194:195]
    v_pk_mul_f32 v[212:213], v[212:213], v[196:197]
    v_pk_mul_f32 v[214:215], v[214:215], v[198:199]
    v_pk_mul_f32 v[216:217], v[216:217], v[200:201]
    v_cvt_pk_bf16_f32 v220, v216, v214
    v_cvt_pk_bf16_f32 v221, v212, v210
    v_cvt_pk_bf16_f32 v222, v208, v206
    v_cvt_pk_bf16_f32 v223, v204, v202
    v_cvt_pk_bf16_f32 v224, v217, v215
    v_cvt_pk_bf16_f32 v225, v213, v211
    v_cvt_pk_bf16_f32 v226, v209, v207
    v_cvt_pk_bf16_f32 v227, v205, v203
    v_min_u32 v220, -2, v220
    v_min_u32 v221, -2, v221
    v_min_u32 v222, -2, v222
    v_min_u32 v223, -2, v223
    v_min_u32 v224, -2, v224
    v_min_u32 v225, -2, v225
    v_min_u32 v226, -2, v226
    v_min_u32 v227, -2, v227
    ds_write_b128 v228, v[220:223]
    ds_write_b128 v228, v[224:227] offset:128
    s_waitcnt lgkmcnt(0)
    s_barrier
    ds_read_b128 v[220:223], v229
    ds_read_b128 v[224:227], v229 offset:4096
    s_mov_b32 s82, 0x100000
    s_mov_b32 s83, 0x120000
    s_waitcnt lgkmcnt(1)
    buffer_store_dwordx4 v[220:223], v150, s[16:19], s82 offen sc1
    s_waitcnt lgkmcnt(0)
    buffer_store_dwordx4 v[224:227], v150, s[16:19], s83 offen sc1
    v_and_b32 v2, 63, v0
    s_lshl_b32 s62, s86, 5
    s_lshl_b32 s63, s52, 3
    s_add_u32 s62, s62, s63
    s_lshl_b32 s62, s62, 7
    v_lshl_add_u32 v42, v2, 7, s62
    v_cmp_gt_u32 vcc, 8, v2
    s_nop 1
    v_cndmask_b32 v42, v249, v42, vcc
    buffer_load_dword v43, v42, s[16:19], 0 offen sc1
    v_mov_b32 v4, -1
    v_mov_b32 v5, -1
    v_mov_b32 v6, -1
    v_mov_b32 v7, -1
    s_mov_b32 s82, 0x300000
    buffer_store_dwordx4 v[4:7], v230, s[16:19], s82 offen sc1
    s_mov_b32 s83, 0x301000
    buffer_store_dwordx4 v[4:7], v230, s[16:19], s83 offen sc1
    v_lshrrev_b32 v2, 7, v0
    v_and_b32 v3, 127, v0
    v_bfe_u32 v93, v0, 5, 1
    v_mul_u32_u24 v93, 4608, v93
    v_bfe_u32 v94, v0, 4, 1
    v_mul_u32_u24 v94, 2304, v94
    v_add_u32 v93, v93, v94
    v_and_b32 v94, 15, v0
    v_lshl_add_u32 v93, v94, 4, v93
    v_mov_b32 v96, 0
    v_mov_b32 v97, 0
    v_mov_b32 v98, 0
    v_mov_b32 v99, 0
    ds_write_b128 v93, v[96:99]
    v_mul_u32_u24 v95, 4608, v2
    v_and_b32 v109, 1, v3
    v_mul_u32_u24 v109, 2304, v109
    v_add_u32 v109, v109, v95
    v_lshrrev_b32 v94, 1, v3
    v_lshl_add_u32 v109, v94, 4, v109
    v_mul_u32_u24 v110, 16640, v2
    v_lshl_add_u32 v110, v3, 4, v110
    v_add_u32 v110, 9216, v110
    s_waitcnt vmcnt(5)
    v_alignbit_b32 v112, v65, v64, 16
    v_alignbit_b32 v113, v66, v65, 16
    v_alignbit_b32 v114, v67, v66, 16
    v_alignbit_b32 v115, v68, v67, 16
    v_mov_b32 v116, v65
    v_mov_b32 v117, v66
    v_mov_b32 v118, v67
    v_mov_b32 v119, v68
    v_alignbit_b32 v120, v66, v65, 16
    v_alignbit_b32 v121, v67, v66, 16
    v_alignbit_b32 v122, v68, v67, 16
    v_alignbit_b32 v123, v69, v68, 16
    ds_write_b128 v110, v[112:115] offset:0
    ds_write_b128 v110, v[116:119] offset:4160
    ds_write_b128 v110, v[120:123] offset:8320
    ds_write_b128 v110, v[66:69] offset:12480
    s_nop 1
    v_alignbit_b32 v112, v73, v72, 16
    v_alignbit_b32 v113, v74, v73, 16
    v_alignbit_b32 v114, v75, v74, 16
    v_alignbit_b32 v115, v76, v75, 16
    v_mov_b32 v116, v73
    v_mov_b32 v117, v74
    v_mov_b32 v118, v75
    v_mov_b32 v119, v76
    v_alignbit_b32 v120, v74, v73, 16
    v_alignbit_b32 v121, v75, v74, 16
    v_alignbit_b32 v122, v76, v75, 16
    v_alignbit_b32 v123, v77, v76, 16
    ds_write_b128 v110, v[112:115] offset:2048
    ds_write_b128 v110, v[116:119] offset:6208
    ds_write_b128 v110, v[120:123] offset:10368
    ds_write_b128 v110, v[74:77] offset:14528
    s_nop 1
    v_cmp_gt_u32 vcc, 2, v3
    s_and_saveexec_b64 s[62:63], vcc
    s_cbranch_execz SKIP3
    v_alignbit_b32 v112, v81, v80, 16
    v_alignbit_b32 v113, v82, v81, 16
    v_alignbit_b32 v114, v83, v82, 16
    v_alignbit_b32 v115, v84, v83, 16
    v_mov_b32 v116, v81
    v_mov_b32 v117, v82
    v_mov_b32 v118, v83
    v_mov_b32 v119, v84
    v_alignbit_b32 v120, v82, v81, 16
    v_alignbit_b32 v121, v83, v82, 16
    v_alignbit_b32 v122, v84, v83, 16
    v_alignbit_b32 v123, v85, v84, 16
    ds_write_b128 v110, v[112:115] offset:4096
    ds_write_b128 v110, v[116:119] offset:8256
    ds_write_b128 v110, v[120:123] offset:12416
    ds_write_b128 v110, v[82:85] offset:16576
SKIP3:
    s_mov_b64 exec, s[62:63]
    s_nop 1
    s_lshr_b32 s89, s52, 1
    s_and_b32 s87, s52, 1
    v_and_b32 v3, 15, v0
    v_bfe_u32 v4, v0, 4, 2
    v_and_b32 v5, 3, v3
    v_mul_u32_u24 v5, 4160, v5
    v_lshrrev_b32 v6, 2, v3
    v_lshl_add_u32 v5, v6, 3, v5
    v_lshl_add_u32 v5, v4, 4, v5
    s_mul_i32 s62, s89, 16640
    s_add_u32 s62, s62, 9216
    v_add_u32 v56, s62, v5
    v_and_b32 v5, 1, v4
    v_xor_b32 v5, 1, v5
    v_mul_u32_u24 v5, 2304, v5
    v_lshrrev_b32 v6, 1, v4
    v_sub_u32 v6, v3, v6
    v_add_u32 v6, 2, v6
    v_lshl_add_u32 v5, v6, 4, v5
    s_mul_i32 s81, s89, 4608
    v_add_u32 v57, s81, v5
    v_lshlrev_b32 v58, 7, v0
    v_lshrrev_b32 v5, 1, v4
    v_mul_u32_u24 v6, 2304, v5
    v_lshl_add_u32 v6, v3, 4, v6
    v_and_b32 v7, 1, v4
    v_lshlrev_b32 v2, 3, v7
    v_sub_u32 v6, v6, v2
    s_add_u32 s81, s81, 264
    v_add_u32 v60, s81, v6
    v_bfe_u32 v6, v3, 2, 1
    v_xor_b32 v5, v5, v6
    v_lshlrev_b32 v5, 4, v5
    v_lshl_add_u32 v5, v3, 5, v5
    v_add_u32 v5, v5, v2
    s_lshl_b32 s63, s89, 12
    s_add_u32 s63, s63, 155648
    v_add_u32 v61, s63, v5
    v_and_b32 v5, 63, v0
    v_bfe_u32 v6, v5, 1, 1
    v_bfe_u32 v7, v5, 4, 1
    v_xor_b32 v6, v6, v7
    v_lshlrev_b32 v6, 4, v6
    v_lshrrev_b32 v7, 2, v5
    v_lshl_add_u32 v6, v7, 5, v6
    v_and_b32 v7, 1, v5
    v_lshl_add_u32 v6, v7, 12, v6
    s_lshl_b32 s63, s52, 10
    s_add_u32 s63, s63, 155648
    v_add_u32 v62, s63, v6
    s_mul_i32 s63, s2, 8192
    s_lshl_b32 s81, s52, 11
    s_add_u32 s63, s63, s81
    v_lshl_add_u32 v63, v5, 4, s63
    s_mov_b32 s80, 0
    s_waitcnt vmcnt(2)
    s_branch CA_2_chk
CA_2:
    buffer_load_dword v43, v42, s[16:19], 0 offen offset:0 sc1
    s_waitcnt vmcnt(0)
CA_2_chk:
    v_cmp_le_i32 vcc, 0, v42
    v_mov_b32 v44, s3
    s_nop 0
    v_cndmask_b32 v43, v44, v43, vcc
    v_cmp_ne_u32 vcc, s3, v43
    s_cbranch_vccz CA_2_ok
    s_add_u32 s80, s80, 1
    s_cmp_gt_u32 s80, 40000
    s_cbranch_scc1 CA_2_ok
    s_sleep 2
    s_branch CA_2
CA_2_ok:
    s_barrier
    s_mov_b32 s80, 0
PX_3:
    s_mov_b32 s82, 0x100000
    buffer_load_dwordx4 v[100:103], v245, s[16:19], s82 offen sc1
    buffer_load_dwordx4 v[104:107], v245, s[16:19], s82 offen offset:2048 sc1
    s_waitcnt vmcnt(0)
PX_3_chk:
    v_max3_u32 v112, v100, v101, v102
    v_max3_u32 v113, v103, v104, v105
    v_max3_u32 v112, v112, v106, v107
    v_max_u32 v112, v112, v113
    v_cmp_eq_u32 vcc, -1, v112
    s_cbranch_vccz PX_3_ok
    s_add_u32 s80, s80, 1
    s_cmp_gt_u32 s80, 40000
    s_cbranch_scc1 PX_3_ok
    s_sleep 1
    s_branch PX_3
PX_3_ok:
    ds_write_b128 v109, v[100:103] offset:256
    ds_write_b128 v109, v[104:107] offset:1280
    s_mov_b32 s68, s4
    s_and_b32 s69, s5, 0xffff
    s_mov_b32 s70, 0x1c0000
    s_mov_b32 s71, 0x20000
    s_movk_i32 s62, 4480
    buffer_load_dword v8, v37, s[68:71], 0 offen offset:0 nt
    buffer_load_dword v9, v37, s[68:71], 0 offen offset:896 nt
    buffer_load_dword v10, v37, s[68:71], 0 offen offset:1792 nt
    buffer_load_dword v11, v37, s[68:71], 0 offen offset:2688 nt
    buffer_load_dword v12, v37, s[68:71], 0 offen offset:3584 nt
    buffer_load_dword v13, v37, s[68:71], s62 offen offset:0 nt
    buffer_load_dword v14, v37, s[68:71], s62 offen offset:896 nt
    buffer_load_dword v15, v37, s[68:71], s62 offen offset:1792 nt
    s_waitcnt lgkmcnt(0)
    s_barrier
    s_cmp_lg_u32 s52, 0
    s_cbranch_scc1 PUB_4
    s_lshl_b32 s62, s2, 7
    v_mov_b32 v2, s3
    s_mov_b64 exec, 1
    buffer_store_dword v2, off, s[16:19], s62 offset:8 sc1
    s_mov_b64 exec, -1
PUB_4:
    s_cmp_eq_u32 s87, 0
    s_cbranch_scc0 CV_H1
    ds_read_b64 v[96:97], v56 offset:0
    ds_read_b64 v[98:99], v56 offset:8
    ds_read_b128 v[208:211], v57 offset:224
    ds_read_b128 v[176:179], v57 offset:480
    ds_read_b128 v[144:147], v57 offset:1760
    ds_read_b128 v[112:115], v57 offset:2016
    ds_read_b64 v[100:101], v56 offset:64
    ds_read_b64 v[102:103], v56 offset:72
    ds_read_b128 v[212:215], v57 offset:192
    ds_read_b128 v[180:183], v57 offset:448
    ds_read_b128 v[148:151], v57 offset:1728
    ds_read_b128 v[116:119], v57 offset:1984
    s_waitcnt lgkmcnt(6)
    ds_read_b64 v[104:105], v56 offset:128
    ds_read_b64 v[106:107], v56 offset:136
    ds_read_b128 v[216:219], v57 offset:160
    ds_read_b128 v[184:187], v57 offset:416
    ds_read_b128 v[152:155], v57 offset:1696
    ds_read_b128 v[120:123], v57 offset:1952
    v_mfma_f32_16x16x32_bf16 v[64:67], v[96:99], v[208:211], 0
    s_add_u32 m0, s61, 0
    s_add_u32 s92, s92, 57344
    s_cmp_eq_u32 s92, 0x1c0000
    s_cselect_b32 s92, 0x0, s92
    buffer_load_dwordx4 v24, s[20:23], s92 offen lds
    buffer_load_dwordx4 v25, s[20:23], s92 offen offset:1024 lds
    v_mfma_f32_16x16x32_bf16 v[68:71], v[96:99], v[176:179], 0
    v_mfma_f32_16x16x32_bf16 v[72:75], v[96:99], v[144:147], 0
    v_mfma_f32_16x16x32_bf16 v[76:79], v[96:99], v[112:115], 0
    s_waitcnt lgkmcnt(6)
    ds_read_b64 v[108:109], v56 offset:192
    ds_read_b64 v[110:111], v56 offset:200
    ds_read_b128 v[220:223], v57 offset:128
    ds_read_b128 v[188:191], v57 offset:384
    ds_read_b128 v[156:159], v57 offset:1664
    ds_read_b128 v[124:127], v57 offset:1920
    v_mfma_f32_16x16x32_bf16 v[64:67], v[100:103], v[212:215], v[64:67]
    v_mfma_f32_16x16x32_bf16 v[68:71], v[100:103], v[180:183], v[68:71]
    v_mfma_f32_16x16x32_bf16 v[72:75], v[100:103], v[148:151], v[72:75]
    v_mfma_f32_16x16x32_bf16 v[76:79], v[100:103], v[116:119], v[76:79]
    s_waitcnt lgkmcnt(6)
    ds_read_b64 v[40:41], v56 offset:256
    ds_read_b64 v[42:43], v56 offset:264
    ds_read_b128 v[224:227], v57 offset:96
    ds_read_b128 v[192:195], v57 offset:352
    ds_read_b128 v[160:163], v57 offset:1632
    ds_read_b128 v[128:131], v57 offset:1888
    v_mfma_f32_16x16x32_bf16 v[64:67], v[104:107], v[216:219], v[64:67]
    s_add_u32 m0, s61, 8192
    s_add_u32 s92, s92, 57344
    s_cmp_eq_u32 s92, 0x1c0000
    s_cselect_b32 s92, 0x0, s92
    buffer_load_dwordx4 v24, s[20:23], s92 offen lds
    buffer_load_dwordx4 v25, s[20:23], s92 offen offset:1024 lds
    v_mfma_f32_16x16x32_bf16 v[68:71], v[104:107], v[184:187], v[68:71]
    v_mfma_f32_16x16x32_bf16 v[72:75], v[104:107], v[152:155], v[72:75]
    v_mfma_f32_16x16x32_bf16 v[76:79], v[104:107], v[120:123], v[76:79]
    s_waitcnt lgkmcnt(6)
    ds_read_b64 v[44:45], v56 offset:320
    ds_read_b64 v[46:47], v56 offset:328
    ds_read_b128 v[228:231], v57 offset:64
    ds_read_b128 v[196:199], v57 offset:320
    ds_read_b128 v[164:167], v57 offset:1600
    ds_read_b128 v[132:135], v57 offset:1856
    v_mfma_f32_16x16x32_bf16 v[64:67], v[108:111], v[220:223], v[64:67]
    v_mfma_f32_16x16x32_bf16 v[68:71], v[108:111], v[188:191], v[68:71]
    v_mfma_f32_16x16x32_bf16 v[72:75], v[108:111], v[156:159], v[72:75]
    v_mfma_f32_16x16x32_bf16 v[76:79], v[108:111], v[124:127], v[76:79]
    s_waitcnt lgkmcnt(6)
    ds_read_b64 v[48:49], v56 offset:384
    ds_read_b64 v[50:51], v56 offset:392
    ds_read_b128 v[232:235], v57 offset:32
    ds_read_b128 v[200:203], v57 offset:288
    ds_read_b128 v[168:171], v57 offset:1568
    ds_read_b128 v[136:139], v57 offset:1824
    v_mfma_f32_16x16x32_bf16 v[64:67], v[40:43], v[224:227], v[64:67]
    s_add_u32 m0, s61, 16384
    s_add_u32 s92, s92, 57344
    s_cmp_eq_u32 s92, 0x1c0000
    s_cselect_b32 s92, 0x0, s92
    buffer_load_dwordx4 v24, s[20:23], s92 offen lds
    buffer_load_dwordx4 v25, s[20:23], s92 offen offset:1024 lds
    v_mfma_f32_16x16x32_bf16 v[68:71], v[40:43], v[192:195], v[68:71]
    v_mfma_f32_16x16x32_bf16 v[72:75], v[40:43], v[160:163], v[72:75]
    v_mfma_f32_16x16x32_bf16 v[76:79], v[40:43], v[128:131], v[76:79]
    s_waitcnt lgkmcnt(6)
    ds_read_b64 v[52:53], v56 offset:448
    ds_read_b64 v[54:55], v56 offset:456
    ds_read_b128 v[236:239], v57 offset:0
    ds_read_b128 v[204:207], v57 offset:256
    ds_read_b128 v[172:175], v57 offset:1536
    ds_read_b128 v[140:143], v57 offset:1792
    ds_read_b64 v[96:97], v56 offset:512
    ds_read_b64 v[98:99], v56 offset:520
    ds_read_b128 v[112:115], v57 offset:1504
    v_mfma_f32_16x16x32_bf16 v[64:67], v[44:47], v[228:231], v[64:67]
    v_mfma_f32_16x16x32_bf16 v[68:71], v[44:47], v[196:199], v[68:71]
    v_mfma_f32_16x16x32_bf16 v[72:75], v[44:47], v[164:167], v[72:75]
    v_mfma_f32_16x16x32_bf16 v[76:79], v[44:47], v[132:135], v[76:79]
    s_waitcnt lgkmcnt(9)
    ds_read_b64 v[100:101], v56 offset:576
    ds_read_b64 v[102:103], v56 offset:584
    ds_read_b128 v[116:119], v57 offset:1472
    ds_read_b64 v[104:105], v56 offset:640
    ds_read_b64 v[106:107], v56 offset:648
    ds_read_b128 v[120:123], v57 offset:1440
    v_mfma_f32_16x16x32_bf16 v[64:67], v[48:51], v[232:235], v[64:67]
    s_add_u32 m0, s61, 24576
    s_add_u32 s92, s92, 57344
    s_cmp_eq_u32 s92, 0x1c0000
    s_cselect_b32 s92, 0x0, s92
    buffer_load_dwordx4 v24, s[20:23], s92 offen lds
    buffer_load_dwordx4 v25, s[20:23], s92 offen offset:1024 lds
    v_mfma_f32_16x16x32_bf16 v[68:71], v[48:51], v[200:203], v[68:71]
    v_mfma_f32_16x16x32_bf16 v[72:75], v[48:51], v[168:171], v[72:75]
    v_mfma_f32_16x16x32_bf16 v[76:79], v[48:51], v[136:139], v[76:79]
    s_waitcnt lgkmcnt(9)
    ds_read_b64 v[108:109], v56 offset:704
    ds_read_b64 v[110:111], v56 offset:712
    ds_read_b128 v[124:127], v57 offset:1408
    ds_read_b64 v[40:41], v56 offset:768
    ds_read_b64 v[42:43], v56 offset:776
    ds_read_b128 v[128:131], v57 offset:1376
    v_mfma_f32_16x16x32_bf16 v[64:67], v[52:55], v[236:239], v[64:67]
    v_mfma_f32_16x16x32_bf16 v[68:71], v[52:55], v[204:207], v[68:71]
    v_mfma_f32_16x16x32_bf16 v[72:75], v[52:55], v[172:175], v[72:75]
    v_mfma_f32_16x16x32_bf16 v[76:79], v[52:55], v[140:143], v[76:79]
    s_waitcnt lgkmcnt(12)
    ds_read_b64 v[44:45], v56 offset:832
    ds_read_b64 v[46:47], v56 offset:840
    ds_read_b128 v[132:135], v57 offset:1344
    v_mfma_f32_16x16x32_bf16 v[68:71], v[96:99], v[208:211], v[68:71]
    v_mfma_f32_16x16x32_bf16 v[72:75], v[96:99], v[112:115], v[72:75]
    v_mfma_f32_16x16x32_bf16 v[76:79], v[96:99], v[144:147], v[76:79]
    s_waitcnt lgkmcnt(12)
    ds_read_b64 v[48:49], v56 offset:896
    ds_read_b64 v[50:51], v56 offset:904
    ds_read_b128 v[136:139], v57 offset:1312
    v_mfma_f32_16x16x32_bf16 v[68:71], v[100:103], v[212:215], v[68:71]
    v_mfma_f32_16x16x32_bf16 v[72:75], v[100:103], v[116:119], v[72:75]
    v_mfma_f32_16x16x32_bf16 v[76:79], v[100:103], v[148:151], v[76:79]
    s_waitcnt lgkmcnt(12)
    ds_read_b64 v[52:53], v56 offset:960
    ds_read_b64 v[54:55], v56 offset:968
    ds_read_b128 v[140:143], v57 offset:1280
    v_mfma_f32_16x16x32_bf16 v[68:71], v[104:107], v[216:219], v[68:71]
    v_mfma_f32_16x16x32_bf16 v[72:75], v[104:107], v[120:123], v[72:75]
    v_mfma_f32_16x16x32_bf16 v[76:79], v[104:107], v[152:155], v[76:79]
    s_waitcnt lgkmcnt(12)
    ds_read_b64 v[96:97], v56 offset:1024
    ds_read_b64 v[98:99], v56 offset:1032
    ds_read_b128 v[144:147], v57 offset:1248
    v_mfma_f32_16x16x32_bf16 v[68:71], v[108:111], v[220:223], v[68:71]
    v_mfma_f32_16x16x32_bf16 v[72:75], v[108:111], v[124:127], v[72:75]
    v_mfma_f32_16x16x32_bf16 v[76:79], v[108:111], v[156:159], v[76:79]
    s_waitcnt lgkmcnt(12)
    ds_read_b64 v[100:101], v56 offset:1088
    ds_read_b64 v[102:103], v56 offset:1096
    ds_read_b128 v[148:151], v57 offset:1216
    v_mfma_f32_16x16x32_bf16 v[68:71], v[40:43], v[224:227], v[68:71]
    v_mfma_f32_16x16x32_bf16 v[72:75], v[40:43], v[128:131], v[72:75]
    v_mfma_f32_16x16x32_bf16 v[76:79], v[40:43], v[160:163], v[76:79]
    s_waitcnt lgkmcnt(12)
    ds_read_b64 v[104:105], v56 offset:1152
    ds_read_b64 v[106:107], v56 offset:1160
    ds_read_b128 v[152:155], v57 offset:1184
    v_mfma_f32_16x16x32_bf16 v[68:71], v[44:47], v[228:231], v[68:71]
    v_mfma_f32_16x16x32_bf16 v[72:75], v[44:47], v[132:135], v[72:75]
    v_mfma_f32_16x16x32_bf16 v[76:79], v[44:47], v[164:167], v[76:79]
    s_waitcnt lgkmcnt(12)
    ds_read_b64 v[108:109], v56 offset:1216
    ds_read_b64 v[110:111], v56 offset:1224
    ds_read_b128 v[156:159], v57 offset:1152
    v_mfma_f32_16x16x32_bf16 v[68:71], v[48:51], v[232:235], v[68:71]
    v_mfma_f32_16x16x32_bf16 v[72:75], v[48:51], v[136:139], v[72:75]
    v_mfma_f32_16x16x32_bf16 v[76:79], v[48:51], v[168:171], v[76:79]
    s_waitcnt lgkmcnt(12)
    ds_read_b64 v[40:41], v56 offset:1280
    ds_read_b64 v[42:43], v56 offset:1288
    ds_read_b128 v[160:163], v57 offset:1120
    v_mfma_f32_16x16x32_bf16 v[68:71], v[52:55], v[236:239], v[68:71]
    v_mfma_f32_16x16x32_bf16 v[72:75], v[52:55], v[140:143], v[72:75]
    v_mfma_f32_16x16x32_bf16 v[76:79], v[52:55], v[172:175], v[76:79]
    s_waitcnt lgkmcnt(12)
    ds_read_b64 v[44:45], v56 offset:1344
    ds_read_b64 v[46:47], v56 offset:1352
    ds_read_b128 v[164:167], v57 offset:1088
    v_mfma_f32_16x16x32_bf16 v[72:75], v[96:99], v[144:147], v[72:75]
    v_mfma_f32_16x16x32_bf16 v[76:79], v[96:99], v[112:115], v[76:79]
    s_waitcnt lgkmcnt(12)
    ds_read_b64 v[48:49], v56 offset:1408
    ds_read_b64 v[50:51], v56 offset:1416
    ds_read_b128 v[168:171], v57 offset:1056
    v_mfma_f32_16x16x32_bf16 v[72:75], v[100:103], v[148:151], v[72:75]
    v_mfma_f32_16x16x32_bf16 v[76:79], v[100:103], v[116:119], v[76:79]
    s_waitcnt lgkmcnt(12)
    ds_read_b64 v[52:53], v56 offset:1472
    ds_read_b64 v[54:55], v56 offset:1480
    ds_read_b128 v[172:175], v57 offset:1024
    v_mfma_f32_16x16x32_bf16 v[72:75], v[104:107], v[152:155], v[72:75]
    v_mfma_f32_16x16x32_bf16 v[76:79], v[104:107], v[120:123], v[76:79]
    s_waitcnt lgkmcnt(12)
    ds_read_b64 v[96:97], v56 offset:1536
    ds_read_b64 v[98:99], v56 offset:1544
    ds_read_b128 v[112:115], v57 offset:992
    v_mfma_f32_16x16x32_bf16 v[72:75], v[108:111], v[156:159], v[72:75]
    v_mfma_f32_16x16x32_bf16 v[76:79], v[108:111], v[124:127], v[76:79]
    s_waitcnt lgkmcnt(12)
    ds_read_b64 v[100:101], v56 offset:1600
    ds_read_b64 v[102:103], v56 offset:1608
    ds_read_b128 v[116:119], v57 offset:960
    v_mfma_f32_16x16x32_bf16 v[72:75], v[40:43], v[160:163], v[72:75]
    v_mfma_f32_16x16x32_bf16 v[76:79], v[40:43], v[128:131], v[76:79]
    s_waitcnt lgkmcnt(12)
    ds_read_b64 v[104:105], v56 offset:1664
    ds_read_b64 v[106:107], v56 offset:1672
    ds_read_b128 v[120:123], v57 offset:928
    v_mfma_f32_16x16x32_bf16 v[72:75], v[44:47], v[164:167], v[72:75]
    v_mfma_f32_16x16x32_bf16 v[76:79], v[44:47], v[132:135], v[76:79]
    s_waitcnt lgkmcnt(12)
    ds_read_b64 v[108:109], v56 offset:1728
    ds_read_b64 v[110:111], v56 offset:1736
    ds_read_b128 v[124:127], v57 offset:896
    v_mfma_f32_16x16x32_bf16 v[72:75], v[48:51], v[168:171], v[72:75]
    v_mfma_f32_16x16x32_bf16 v[76:79], v[48:51], v[136:139], v[76:79]
    s_waitcnt lgkmcnt(12)
    ds_read_b64 v[40:41], v56 offset:1792
    ds_read_b64 v[42:43], v56 offset:1800
    ds_read_b128 v[128:131], v57 offset:864
    v_mfma_f32_16x16x32_bf16 v[72:75], v[52:55], v[172:175], v[72:75]
    v_mfma_f32_16x16x32_bf16 v[76:79], v[52:55], v[140:143], v[76:79]
    s_waitcnt lgkmcnt(12)
    ds_read_b64 v[44:45], v56 offset:1856
    ds_read_b64 v[46:47], v56 offset:1864
    ds_read_b128 v[132:135], v57 offset:832
    v_mfma_f32_16x16x32_bf16 v[72:75], v[96:99], v[112:115], v[72:75]
    v_mfma_f32_16x16x32_bf16 v[76:79], v[96:99], v[144:147], v[76:79]
    s_waitcnt lgkmcnt(12)
    ds_read_b64 v[48:49], v56 offset:1920
    ds_read_b64 v[50:51], v56 offset:1928
    ds_read_b128 v[136:139], v57 offset:800
    v_mfma_f32_16x16x32_bf16 v[72:75], v[100:103], v[116:119], v[72:75]
    v_mfma_f32_16x16x32_bf16 v[76:79], v[100:103], v[148:151], v[76:79]
    s_waitcnt lgkmcnt(12)
    ds_read_b64 v[52:53], v56 offset:1984
    ds_read_b64 v[54:55], v56 offset:1992
    ds_read_b128 v[140:143], v57 offset:768
    v_mfma_f32_16x16x32_bf16 v[72:75], v[104:107], v[120:123], v[72:75]
    v_mfma_f32_16x16x32_bf16 v[76:79], v[104:107], v[152:155], v[76:79]
    s_waitcnt lgkmcnt(12)
    ds_read_b64 v[96:97], v56 offset:2048
    ds_read_b64 v[98:99], v56 offset:2056
    ds_read_b128 v[144:147], v57 offset:736
    v_mfma_f32_16x16x32_bf16 v[72:75], v[108:111], v[124:127], v[72:75]
    v_mfma_f32_16x16x32_bf16 v[76:79], v[108:111], v[156:159], v[76:79]
    s_waitcnt lgkmcnt(12)
    ds_read_b64 v[100:101], v56 offset:2112
    ds_read_b64 v[102:103], v56 offset:2120
    ds_read_b128 v[148:151], v57 offset:704
    v_mfma_f32_16x16x32_bf16 v[72:75], v[40:43], v[128:131], v[72:75]
    v_mfma_f32_16x16x32_bf16 v[76:79], v[40:43], v[160:163], v[76:79]
    s_waitcnt lgkmcnt(12)
    ds_read_b64 v[104:105], v56 offset:2176
    ds_read_b64 v[106:107], v56 offset:2184
    ds_read_b128 v[152:155], v57 offset:672
    v_mfma_f32_16x16x32_bf16 v[72:75], v[44:47], v[132:135], v[72:75]
    v_mfma_f32_16x16x32_bf16 v[76:79], v[44:47], v[164:167], v[76:79]
    s_waitcnt lgkmcnt(12)
    ds_read_b64 v[108:109], v56 offset:2240
    ds_read_b64 v[110:111], v56 offset:2248
    ds_read_b128 v[156:159], v57 offset:640
    v_mfma_f32_16x16x32_bf16 v[72:75], v[48:51], v[136:139], v[72:75]
    v_mfma_f32_16x16x32_bf16 v[76:79], v[48:51], v[168:171], v[76:79]
    s_waitcnt lgkmcnt(12)
    ds_read_b64 v[40:41], v56 offset:2304
    ds_read_b64 v[42:43], v56 offset:2312
    ds_read_b128 v[160:163], v57 offset:608
    v_mfma_f32_16x16x32_bf16 v[72:75], v[52:55], v[140:143], v[72:75]
    v_mfma_f32_16x16x32_bf16 v[76:79], v[52:55], v[172:175], v[76:79]
    s_waitcnt lgkmcnt(12)
    ds_read_b64 v[44:45], v56 offset:2368
    ds_read_b64 v[46:47], v56 offset:2376
    ds_read_b128 v[164:167], v57 offset:576
    v_mfma_f32_16x16x32_bf16 v[72:75], v[96:99], v[144:147], v[72:75]
    v_mfma_f32_16x16x32_bf16 v[76:79], v[96:99], v[112:115], v[76:79]
    s_waitcnt lgkmcnt(12)
    ds_read_b64 v[48:49], v56 offset:2432
    ds_read_b64 v[50:51], v56 offset:2440
    ds_read_b128 v[168:171], v57 offset:544
    v_mfma_f32_16x16x32_bf16 v[72:75], v[100:103], v[148:151], v[72:75]
    v_mfma_f32_16x16x32_bf16 v[76:79], v[100:103], v[116:119], v[76:79]
    s_waitcnt lgkmcnt(12)
    ds_read_b64 v[52:53], v56 offset:2496
    ds_read_b64 v[54:55], v56 offset:2504
    ds_read_b128 v[172:175], v57 offset:512
    v_mfma_f32_16x16x32_bf16 v[72:75], v[104:107], v[152:155], v[72:75]
    v_mfma_f32_16x16x32_bf16 v[76:79], v[104:107], v[120:123], v[76:79]
    s_waitcnt lgkmcnt(12)
    ds_read_b64 v[96:97], v56 offset:2560
    ds_read_b64 v[98:99], v56 offset:2568
    v_mfma_f32_16x16x32_bf16 v[72:75], v[108:111], v[156:159], v[72:75]
    v_mfma_f32_16x16x32_bf16 v[76:79], v[108:111], v[124:127], v[76:79]
    s_waitcnt lgkmcnt(11)
    ds_read_b64 v[100:101], v56 offset:2624
    ds_read_b64 v[102:103], v56 offset:2632
    ds_read_b64 v[104:105], v56 offset:2688
    ds_read_b64 v[106:107], v56 offset:2696
    v_mfma_f32_16x16x32_bf16 v[72:75], v[40:43], v[160:163], v[72:75]
    v_mfma_f32_16x16x32_bf16 v[76:79], v[40:43], v[128:131], v[76:79]
    s_waitcnt lgkmcnt(12)
    ds_read_b64 v[108:109], v56 offset:2752
    ds_read_b64 v[110:111], v56 offset:2760
    v_mfma_f32_16x16x32_bf16 v[72:75], v[44:47], v[164:167], v[72:75]
    v_mfma_f32_16x16x32_bf16 v[76:79], v[44:47], v[132:135], v[76:79]
    s_waitcnt lgkmcnt(11)
    ds_read_b64 v[40:41], v56 offset:2816
    ds_read_b64 v[42:43], v56 offset:2824
    v_mfma_f32_16x16x32_bf16 v[72:75], v[48:51], v[168:171], v[72:75]
    v_mfma_f32_16x16x32_bf16 v[76:79], v[48:51], v[136:139], v[76:79]
    s_waitcnt lgkmcnt(10)
    ds_read_b64 v[44:45], v56 offset:2880
    ds_read_b64 v[46:47], v56 offset:2888
    v_mfma_f32_16x16x32_bf16 v[72:75], v[52:55], v[172:175], v[72:75]
    v_mfma_f32_16x16x32_bf16 v[76:79], v[52:55], v[140:143], v[76:79]
    s_waitcnt lgkmcnt(10)
    ds_read_b64 v[48:49], v56 offset:2944
    ds_read_b64 v[50:51], v56 offset:2952
    v_mfma_f32_16x16x32_bf16 v[72:75], v[96:99], v[176:179], v[72:75]
    v_mfma_f32_16x16x32_bf16 v[76:79], v[96:99], v[144:147], v[76:79]
    s_waitcnt lgkmcnt(10)
    ds_read_b64 v[52:53], v56 offset:3008
    ds_read_b64 v[54:55], v56 offset:3016
    v_mfma_f32_16x16x32_bf16 v[72:75], v[100:103], v[180:183], v[72:75]
    v_mfma_f32_16x16x32_bf16 v[76:79], v[100:103], v[148:151], v[76:79]
    s_waitcnt lgkmcnt(10)
    ds_read_b64 v[96:97], v56 offset:3072
    ds_read_b64 v[98:99], v56 offset:3080
    v_mfma_f32_16x16x32_bf16 v[72:75], v[104:107], v[184:187], v[72:75]
    v_mfma_f32_16x16x32_bf16 v[76:79], v[104:107], v[152:155], v[76:79]
    s_waitcnt lgkmcnt(10)
    ds_read_b64 v[100:101], v56 offset:3136
    ds_read_b64 v[102:103], v56 offset:3144
    v_mfma_f32_16x16x32_bf16 v[72:75], v[108:111], v[188:191], v[72:75]
    v_mfma_f32_16x16x32_bf16 v[76:79], v[108:111], v[156:159], v[76:79]
    s_waitcnt lgkmcnt(10)
    ds_read_b64 v[104:105], v56 offset:3200
    ds_read_b64 v[106:107], v56 offset:3208
    v_mfma_f32_16x16x32_bf16 v[72:75], v[40:43], v[192:195], v[72:75]
    v_mfma_f32_16x16x32_bf16 v[76:79], v[40:43], v[160:163], v[76:79]
    s_waitcnt lgkmcnt(10)
    ds_read_b64 v[108:109], v56 offset:3264
    ds_read_b64 v[110:111], v56 offset:3272
    v_mfma_f32_16x16x32_bf16 v[72:75], v[44:47], v[196:199], v[72:75]
    v_mfma_f32_16x16x32_bf16 v[76:79], v[44:47], v[164:167], v[76:79]
    s_waitcnt lgkmcnt(10)
    ds_read_b64 v[40:41], v56 offset:3328
    ds_read_b64 v[42:43], v56 offset:3336
    v_mfma_f32_16x16x32_bf16 v[72:75], v[48:51], v[200:203], v[72:75]
    v_mfma_f32_16x16x32_bf16 v[76:79], v[48:51], v[168:171], v[76:79]
    s_waitcnt lgkmcnt(10)
    ds_read_b64 v[44:45], v56 offset:3392
    ds_read_b64 v[46:47], v56 offset:3400
    v_mfma_f32_16x16x32_bf16 v[72:75], v[52:55], v[204:207], v[72:75]
    v_mfma_f32_16x16x32_bf16 v[76:79], v[52:55], v[172:175], v[76:79]
    buffer_load_dword v59, v58, s[16:19], 0 offen offset:8 sc1
    s_waitcnt lgkmcnt(10)
    ds_read_b64 v[48:49], v56 offset:3456
    ds_read_b64 v[50:51], v56 offset:3464
    v_mfma_f32_16x16x32_bf16 v[72:75], v[96:99], v[208:211], v[72:75]
    v_mfma_f32_16x16x32_bf16 v[76:79], v[96:99], v[176:179], v[76:79]
    s_waitcnt lgkmcnt(10)
    ds_read_b64 v[52:53], v56 offset:3520
    ds_read_b64 v[54:55], v56 offset:3528
    v_mfma_f32_16x16x32_bf16 v[72:75], v[100:103], v[212:215], v[72:75]
    v_mfma_f32_16x16x32_bf16 v[76:79], v[100:103], v[180:183], v[76:79]
    s_waitcnt lgkmcnt(10)
    ds_read_b64 v[96:97], v56 offset:3584
    ds_read_b64 v[98:99], v56 offset:3592
    v_mfma_f32_16x16x32_bf16 v[72:75], v[104:107], v[216:219], v[72:75]
    v_mfma_f32_16x16x32_bf16 v[76:79], v[104:107], v[184:187], v[76:79]
    s_waitcnt lgkmcnt(10)
    ds_read_b64 v[100:101], v56 offset:3648
    ds_read_b64 v[102:103], v56 offset:3656
    v_mfma_f32_16x16x32_bf16 v[72:75], v[108:111], v[220:223], v[72:75]
    v_mfma_f32_16x16x32_bf16 v[76:79], v[108:111], v[188:191], v[76:79]
    s_waitcnt lgkmcnt(10)
    ds_read_b64 v[104:105], v56 offset:3712
    ds_read_b64 v[106:107], v56 offset:3720
    v_mfma_f32_16x16x32_bf16 v[72:75], v[40:43], v[224:227], v[72:75]
    v_mfma_f32_16x16x32_bf16 v[76:79], v[40:43], v[192:195], v[76:79]
    s_waitcnt lgkmcnt(10)
    ds_read_b64 v[108:109], v56 offset:3776
    ds_read_b64 v[110:111], v56 offset:3784
    v_mfma_f32_16x16x32_bf16 v[72:75], v[44:47], v[228:231], v[72:75]
    v_mfma_f32_16x16x32_bf16 v[76:79], v[44:47], v[196:199], v[76:79]
    s_waitcnt lgkmcnt(10)
    ds_read_b64 v[40:41], v56 offset:3840
    ds_read_b64 v[42:43], v56 offset:3848
    v_mfma_f32_16x16x32_bf16 v[72:75], v[48:51], v[232:235], v[72:75]
    v_mfma_f32_16x16x32_bf16 v[76:79], v[48:51], v[200:203], v[76:79]
    s_waitcnt lgkmcnt(10)
    ds_read_b64 v[44:45], v56 offset:3904
    ds_read_b64 v[46:47], v56 offset:3912
    v_mfma_f32_16x16x32_bf16 v[72:75], v[52:55], v[236:239], v[72:75]
    v_mfma_f32_16x16x32_bf16 v[76:79], v[52:55], v[204:207], v[76:79]
    s_waitcnt lgkmcnt(10)
    ds_read_b64 v[48:49], v56 offset:3968
    ds_read_b64 v[50:51], v56 offset:3976
    v_mfma_f32_16x16x32_bf16 v[76:79], v[96:99], v[208:211], v[76:79]
    s_waitcnt lgkmcnt(10)
    ds_read_b64 v[52:53], v56 offset:4032
    ds_read_b64 v[54:55], v56 offset:4040
    v_mfma_f32_16x16x32_bf16 v[76:79], v[100:103], v[212:215], v[76:79]
    s_waitcnt lgkmcnt(10)
    v_mfma_f32_16x16x32_bf16 v[76:79], v[104:107], v[216:219], v[76:79]
    s_waitcnt lgkmcnt(8)
    v_mfma_f32_16x16x32_bf16 v[76:79], v[108:111], v[220:223], v[76:79]
    s_waitcnt lgkmcnt(6)
    v_mfma_f32_16x16x32_bf16 v[76:79], v[40:43], v[224:227], v[76:79]
    s_waitcnt lgkmcnt(4)
    v_mfma_f32_16x16x32_bf16 v[76:79], v[44:47], v[228:231], v[76:79]
    s_waitcnt lgkmcnt(2)
    v_mfma_f32_16x16x32_bf16 v[76:79], v[48:51], v[232:235], v[76:79]
    s_waitcnt lgkmcnt(0)
    v_mfma_f32_16x16x32_bf16 v[76:79], v[52:55], v[236:239], v[76:79]
    ds_read_b64 v[96:97], v60 offset:0
    ds_read_b64 v[98:99], v60 offset:256
    ds_read_b64 v[100:101], v60 offset:1536
    ds_read_b64 v[102:103], v60 offset:1792
    s_lshl_b32 s62, s88, 16
    s_and_b32 s63, s88, 0xffff0000
    s_cmp_eq_u32 s89, 0
    s_cselect_b32 s62, s62, s63
    s_waitcnt lgkmcnt(0)
    v_lshlrev_b32 v115, 16, v96
    v_and_b32 v114, 0xffff0000, v96
    v_lshlrev_b32 v113, 16, v97
    v_and_b32 v112, 0xffff0000, v97
    v_lshlrev_b32 v119, 16, v98
    v_and_b32 v118, 0xffff0000, v98
    v_lshlrev_b32 v117, 16, v99
    v_and_b32 v116, 0xffff0000, v99
    v_lshlrev_b32 v123, 16, v100
    v_and_b32 v122, 0xffff0000, v100
    v_lshlrev_b32 v121, 16, v101
    v_and_b32 v120, 0xffff0000, v101
    v_lshlrev_b32 v127, 16, v102
    v_and_b32 v126, 0xffff0000, v102
    v_lshlrev_b32 v125, 16, v103
    v_and_b32 v124, 0xffff0000, v103
    v_fmac_f32 v64, s62, v112
    v_fmac_f32 v65, s62, v113
    v_fmac_f32 v66, s62, v114
    v_fmac_f32 v67, s62, v115
    v_fmac_f32 v68, s62, v116
    v_fmac_f32 v69, s62, v117
    v_fmac_f32 v70, s62, v118
    v_fmac_f32 v71, s62, v119
    v_fmac_f32 v72, s62, v120
    v_fmac_f32 v73, s62, v121
    v_fmac_f32 v74, s62, v122
    v_fmac_f32 v75, s62, v123
    v_fmac_f32 v76, s62, v124
    v_fmac_f32 v77, s62, v125
    v_fmac_f32 v78, s62, v126
    v_fmac_f32 v79, s62, v127
    v_cvt_pk_bf16_f32 v96, v64, v65
    v_cvt_pk_bf16_f32 v97, v66, v67
    v_cvt_pk_bf16_f32 v98, v68, v69
    v_cvt_pk_bf16_f32 v99, v70, v71
    v_cvt_pk_bf16_f32 v100, v72, v73
    v_cvt_pk_bf16_f32 v101, v74, v75
    v_cvt_pk_bf16_f32 v102, v76, v77
    v_cvt_pk_bf16_f32 v103, v78, v79
    v_min_u32 v96, -2, v96
    v_min_u32 v97, -2, v97
    v_min_u32 v98, -2, v98
    v_min_u32 v99, -2, v99
    v_min_u32 v100, -2, v100
    v_min_u32 v101, -2, v101
    v_min_u32 v102, -2, v102
    v_min_u32 v103, -2, v103
    ds_write_b64 v61, v[96:97] offset:0
    ds_write_b64 v61, v[98:99] offset:512
    ds_write_b64 v61, v[100:101] offset:3072
    ds_write_b64 v61, v[102:103] offset:3584
    s_waitcnt lgkmcnt(0)
    s_branch CV_JOIN
CV_H1:
    ds_read_b64 v[96:97], v56 offset:0
    ds_read_b64 v[98:99], v56 offset:8
    ds_read_b128 v[208:211], v57 offset:736
    ds_read_b128 v[176:179], v57 offset:992
    ds_read_b128 v[144:147], v57 offset:1248
    ds_read_b128 v[112:115], v57 offset:1504
    ds_read_b64 v[100:101], v56 offset:64
    ds_read_b64 v[102:103], v56 offset:72
    ds_read_b128 v[212:215], v57 offset:704
    ds_read_b128 v[180:183], v57 offset:960
    ds_read_b128 v[148:151], v57 offset:1216
    ds_read_b128 v[116:119], v57 offset:1472
    s_waitcnt lgkmcnt(6)
    ds_read_b64 v[104:105], v56 offset:128
    ds_read_b64 v[106:107], v56 offset:136
    ds_read_b128 v[216:219], v57 offset:672
    ds_read_b128 v[184:187], v57 offset:928
    ds_read_b128 v[152:155], v57 offset:1184
    ds_read_b128 v[120:123], v57 offset:1440
    v_mfma_f32_16x16x32_bf16 v[64:67], v[96:99], v[208:211], 0
    s_add_u32 m0, s61, 0
    s_add_u32 s92, s92, 57344
    s_cmp_eq_u32 s92, 0x1c0000
    s_cselect_b32 s92, 0x0, s92
    buffer_load_dwordx4 v24, s[20:23], s92 offen lds
    buffer_load_dwordx4 v25, s[20:23], s92 offen offset:1024 lds
    v_mfma_f32_16x16x32_bf16 v[68:71], v[96:99], v[176:179], 0
    v_mfma_f32_16x16x32_bf16 v[72:75], v[96:99], v[144:147], 0
    v_mfma_f32_16x16x32_bf16 v[76:79], v[96:99], v[112:115], 0
    s_waitcnt lgkmcnt(6)
    ds_read_b64 v[108:109], v56 offset:192
    ds_read_b64 v[110:111], v56 offset:200
    ds_read_b128 v[220:223], v57 offset:640
    ds_read_b128 v[188:191], v57 offset:896
    ds_read_b128 v[156:159], v57 offset:1152
    ds_read_b128 v[124:127], v57 offset:1408
    v_mfma_f32_16x16x32_bf16 v[64:67], v[100:103], v[212:215], v[64:67]
    v_mfma_f32_16x16x32_bf16 v[68:71], v[100:103], v[180:183], v[68:71]
    v_mfma_f32_16x16x32_bf16 v[72:75], v[100:103], v[148:151], v[72:75]
    v_mfma_f32_16x16x32_bf16 v[76:79], v[100:103], v[116:119], v[76:79]
    s_waitcnt lgkmcnt(6)
    ds_read_b64 v[40:41], v56 offset:256
    ds_read_b64 v[42:43], v56 offset:264
    ds_read_b128 v[224:227], v57 offset:608
    ds_read_b128 v[192:195], v57 offset:864
    ds_read_b128 v[160:163], v57 offset:1120
    ds_read_b128 v[128:131], v57 offset:1376
    v_mfma_f32_16x16x32_bf16 v[64:67], v[104:107], v[216:219], v[64:67]
    s_add_u32 m0, s61, 8192
    s_add_u32 s92, s92, 57344
    s_cmp_eq_u32 s92, 0x1c0000
    s_cselect_b32 s92, 0x0, s92
    buffer_load_dwordx4 v24, s[20:23], s92 offen lds
    buffer_load_dwordx4 v25, s[20:23], s92 offen offset:1024 lds
    v_mfma_f32_16x16x32_bf16 v[68:71], v[104:107], v[184:187], v[68:71]
    v_mfma_f32_16x16x32_bf16 v[72:75], v[104:107], v[152:155], v[72:75]
    v_mfma_f32_16x16x32_bf16 v[76:79], v[104:107], v[120:123], v[76:79]
    s_waitcnt lgkmcnt(6)
    ds_read_b64 v[44:45], v56 offset:320
    ds_read_b64 v[46:47], v56 offset:328
    ds_read_b128 v[228:231], v57 offset:576
    ds_read_b128 v[196:199], v57 offset:832
    ds_read_b128 v[164:167], v57 offset:1088
    ds_read_b128 v[132:135], v57 offset:1344
    v_mfma_f32_16x16x32_bf16 v[64:67], v[108:111], v[220:223], v[64:67]
    v_mfma_f32_16x16x32_bf16 v[68:71], v[108:111], v[188:191], v[68:71]
    v_mfma_f32_16x16x32_bf16 v[72:75], v[108:111], v[156:159], v[72:75]
    v_mfma_f32_16x16x32_bf16 v[76:79], v[108:111], v[124:127], v[76:79]
    s_waitcnt lgkmcnt(6)
    ds_read_b64 v[48:49], v56 offset:384
    ds_read_b64 v[50:51], v56 offset:392
    ds_read_b128 v[232:235], v57 offset:544
    ds_read_b128 v[200:203], v57 offset:800
    ds_read_b128 v[168:171], v57 offset:1056
    ds_read_b128 v[136:139], v57 offset:1312
    v_mfma_f32_16x16x32_bf16 v[64:67], v[40:43], v[224:227], v[64:67]
    s_add_u32 m0, s61, 16384
    s_add_u32 s92, s92, 57344
    s_cmp_eq_u32 s92, 0x1c0000
    s_cselect_b32 s92, 0x0, s92
    buffer_load_dwordx4 v24, s[20:23], s92 offen lds
    buffer_load_dwordx4 v25, s[20:23], s92 offen offset:1024 lds
    v_mfma_f32_16x16x32_bf16 v[68:71], v[40:43], v[192:195], v[68:71]
    v_mfma_f32_16x16x32_bf16 v[72:75], v[40:43], v[160:163], v[72:75]
    v_mfma_f32_16x16x32_bf16 v[76:79], v[40:43], v[128:131], v[76:79]
    s_waitcnt lgkmcnt(6)
    ds_read_b64 v[52:53], v56 offset:448
    ds_read_b64 v[54:55], v56 offset:456
    ds_read_b128 v[236:239], v57 offset:512
    ds_read_b128 v[204:207], v57 offset:768
    ds_read_b128 v[172:175], v57 offset:1024
    ds_read_b128 v[140:143], v57 offset:1280
    ds_read_b64 v[96:97], v56 offset:512
    ds_read_b64 v[98:99], v56 offset:520
    ds_read_b128 v[112:115], v57 offset:480
    v_mfma_f32_16x16x32_bf16 v[64:67], v[44:47], v[228:231], v[64:67]
    v_mfma_f32_16x16x32_bf16 v[68:71], v[44:47], v[196:199], v[68:71]
    v_mfma_f32_16x16x32_bf16 v[72:75], v[44:47], v[164:167], v[72:75]
    v_mfma_f32_16x16x32_bf16 v[76:79], v[44:47], v[132:135], v[76:79]
    s_waitcnt lgkmcnt(9)
    ds_read_b64 v[100:101], v56 offset:576
    ds_read_b64 v[102:103], v56 offset:584
    ds_read_b128 v[116:119], v57 offset:448
    ds_read_b64 v[104:105], v56 offset:640
    ds_read_b64 v[106:107], v56 offset:648
    ds_read_b128 v[120:123], v57 offset:416
    v_mfma_f32_16x16x32_bf16 v[64:67], v[48:51], v[232:235], v[64:67]
    s_add_u32 m0, s61, 24576
    s_add_u32 s92, s92, 57344
    s_cmp_eq_u32 s92, 0x1c0000
    s_cselect_b32 s92, 0x0, s92
    buffer_load_dwordx4 v24, s[20:23], s92 offen lds
    buffer_load_dwordx4 v25, s[20:23], s92 offen offset:1024 lds
    v_mfma_f32_16x16x32_bf16 v[68:71], v[48:51], v[200:203], v[68:71]
    v_mfma_f32_16x16x32_bf16 v[72:75], v[48:51], v[168:171], v[72:75]
    v_mfma_f32_16x16x32_bf16 v[76:79], v[48:51], v[136:139], v[76:79]
    s_waitcnt lgkmcnt(9)
    ds_read_b64 v[108:109], v56 offset:704
    ds_read_b64 v[110:111], v56 offset:712
    ds_read_b128 v[124:127], v57 offset:384
    ds_read_b64 v[40:41], v56 offset:768
    ds_read_b64 v[42:43], v56 offset:776
    ds_read_b128 v[128:131], v57 offset:352
    v_mfma_f32_16x16x32_bf16 v[64:67], v[52:55], v[236:239], v[64:67]
    v_mfma_f32_16x16x32_bf16 v[68:71], v[52:55], v[204:207], v[68:71]
    v_mfma_f32_16x16x32_bf16 v[72:75], v[52:55], v[172:175], v[72:75]
    v_mfma_f32_16x16x32_bf16 v[76:79], v[52:55], v[140:143], v[76:79]
    s_waitcnt lgkmcnt(12)
    ds_read_b64 v[44:45], v56 offset:832
    ds_read_b64 v[46:47], v56 offset:840
    ds_read_b128 v[132:135], v57 offset:320
    v_mfma_f32_16x16x32_bf16 v[64:67], v[96:99], v[112:115], v[64:67]
    v_mfma_f32_16x16x32_bf16 v[68:71], v[96:99], v[208:211], v[68:71]
    v_mfma_f32_16x16x32_bf16 v[72:75], v[96:99], v[176:179], v[72:75]
    v_mfma_f32_16x16x32_bf16 v[76:79], v[96:99], v[144:147], v[76:79]
    s_waitcnt lgkmcnt(12)
    ds_read_b64 v[48:49], v56 offset:896
    ds_read_b64 v[50:51], v56 offset:904
    ds_read_b128 v[136:139], v57 offset:288
    v_mfma_f32_16x16x32_bf16 v[64:67], v[100:103], v[116:119], v[64:67]
    v_mfma_f32_16x16x32_bf16 v[68:71], v[100:103], v[212:215], v[68:71]
    v_mfma_f32_16x16x32_bf16 v[72:75], v[100:103], v[180:183], v[72:75]
    v_mfma_f32_16x16x32_bf16 v[76:79], v[100:103], v[148:151], v[76:79]
    s_waitcnt lgkmcnt(12)
    ds_read_b64 v[52:53], v56 offset:960
    ds_read_b64 v[54:55], v56 offset:968
    ds_read_b128 v[140:143], v57 offset:256
    v_mfma_f32_16x16x32_bf16 v[64:67], v[104:107], v[120:123], v[64:67]
    v_mfma_f32_16x16x32_bf16 v[68:71], v[104:107], v[216:219], v[68:71]
    v_mfma_f32_16x16x32_bf16 v[72:75], v[104:107], v[184:187], v[72:75]
    v_mfma_f32_16x16x32_bf16 v[76:79], v[104:107], v[152:155], v[76:79]
    s_waitcnt lgkmcnt(12)
    ds_read_b64 v[96:97], v56 offset:1024
    ds_read_b64 v[98:99], v56 offset:1032
    ds_read_b128 v[144:147], v57 offset:224
    v_mfma_f32_16x16x32_bf16 v[64:67], v[108:111], v[124:127], v[64:67]
    v_mfma_f32_16x16x32_bf16 v[68:71], v[108:111], v[220:223], v[68:71]
    v_mfma_f32_16x16x32_bf16 v[72:75], v[108:111], v[188:191], v[72:75]
    v_mfma_f32_16x16x32_bf16 v[76:79], v[108:111], v[156:159], v[76:79]
    s_waitcnt lgkmcnt(12)
    ds_read_b64 v[100:101], v56 offset:1088
    ds_read_b64 v[102:103], v56 offset:1096
    ds_read_b128 v[148:151], v57 offset:192
    v_mfma_f32_16x16x32_bf16 v[64:67], v[40:43], v[128:131], v[64:67]
    v_mfma_f32_16x16x32_bf16 v[68:71], v[40:43], v[224:227], v[68:71]
    v_mfma_f32_16x16x32_bf16 v[72:75], v[40:43], v[192:195], v[72:75]
    v_mfma_f32_16x16x32_bf16 v[76:79], v[40:43], v[160:163], v[76:79]
    s_waitcnt lgkmcnt(12)
    ds_read_b64 v[104:105], v56 offset:1152
    ds_read_b64 v[106:107], v56 offset:1160
    ds_read_b128 v[152:155], v57 offset:160
    v_mfma_f32_16x16x32_bf16 v[64:67], v[44:47], v[132:135], v[64:67]
    v_mfma_f32_16x16x32_bf16 v[68:71], v[44:47], v[228:231], v[68:71]
    v_mfma_f32_16x16x32_bf16 v[72:75], v[44:47], v[196:199], v[72:75]
    v_mfma_f32_16x16x32_bf16 v[76:79], v[44:47], v[164:167], v[76:79]
    s_waitcnt lgkmcnt(12)
    ds_read_b64 v[108:109], v56 offset:1216
    ds_read_b64 v[110:111], v56 offset:1224
    ds_read_b128 v[156:159], v57 offset:128
    v_mfma_f32_16x16x32_bf16 v[64:67], v[48:51], v[136:139], v[64:67]
    v_mfma_f32_16x16x32_bf16 v[68:71], v[48:51], v[232:235], v[68:71]
    v_mfma_f32_16x16x32_bf16 v[72:75], v[48:51], v[200:203], v[72:75]
    v_mfma_f32_16x16x32_bf16 v[76:79], v[48:51], v[168:171], v[76:79]
    s_waitcnt lgkmcnt(12)
    ds_read_b64 v[40:41], v56 offset:1280
    ds_read_b64 v[42:43], v56 offset:1288
    ds_read_b128 v[160:163], v57 offset:96
    v_mfma_f32_16x16x32_bf16 v[64:67], v[52:55], v[140:143], v[64:67]
    v_mfma_f32_16x16x32_bf16 v[68:71], v[52:55], v[236:239], v[68:71]
    v_mfma_f32_16x16x32_bf16 v[72:75], v[52:55], v[204:207], v[72:75]
    v_mfma_f32_16x16x32_bf16 v[76:79], v[52:55], v[172:175], v[76:79]
    s_waitcnt lgkmcnt(12)
    ds_read_b64 v[44:45], v56 offset:1344
    ds_read_b64 v[46:47], v56 offset:1352
    ds_read_b128 v[164:167], v57 offset:64
    v_mfma_f32_16x16x32_bf16 v[64:67], v[96:99], v[144:147], v[64:67]
    v_mfma_f32_16x16x32_bf16 v[68:71], v[96:99], v[112:115], v[68:71]
    v_mfma_f32_16x16x32_bf16 v[72:75], v[96:99], v[208:211], v[72:75]
    v_mfma_f32_16x16x32_bf16 v[76:79], v[96:99], v[176:179], v[76:79]
    s_waitcnt lgkmcnt(12)
    ds_read_b64 v[48:49], v56 offset:1408
    ds_read_b64 v[50:51], v56 offset:1416
    ds_read_b128 v[168:171], v57 offset:32
    v_mfma_f32_16x16x32_bf16 v[64:67], v[100:103], v[148:151], v[64:67]
    v_mfma_f32_16x16x32_bf16 v[68:71], v[100:103], v[116:119], v[68:71]
    v_mfma_f32_16x16x32_bf16 v[72:75], v[100:103], v[212:215], v[72:75]
    v_mfma_f32_16x16x32_bf16 v[76:79], v[100:103], v[180:183], v[76:79]
    s_waitcnt lgkmcnt(12)
    ds_read_b64 v[52:53], v56 offset:1472
    ds_read_b64 v[54:55], v56 offset:1480
    ds_read_b128 v[172:175], v57 offset:0
    v_mfma_f32_16x16x32_bf16 v[64:67], v[104:107], v[152:155], v[64:67]
    v_mfma_f32_16x16x32_bf16 v[68:71], v[104:107], v[120:123], v[68:71]
    v_mfma_f32_16x16x32_bf16 v[72:75], v[104:107], v[216:219], v[72:75]
    v_mfma_f32_16x16x32_bf16 v[76:79], v[104:107], v[184:187], v[76:79]
    s_waitcnt lgkmcnt(12)
    ds_read_b64 v[96:97], v56 offset:1536
    ds_read_b64 v[98:99], v56 offset:1544
    v_mfma_f32_16x16x32_bf16 v[64:67], v[108:111], v[156:159], v[64:67]
    v_mfma_f32_16x16x32_bf16 v[68:71], v[108:111], v[124:127], v[68:71]
    v_mfma_f32_16x16x32_bf16 v[72:75], v[108:111], v[220:223], v[72:75]
    v_mfma_f32_16x16x32_bf16 v[76:79], v[108:111], v[188:191], v[76:79]
    s_waitcnt lgkmcnt(11)
    ds_read_b64 v[100:101], v56 offset:1600
    ds_read_b64 v[102:103], v56 offset:1608
    ds_read_b64 v[104:105], v56 offset:1664
    ds_read_b64 v[106:107], v56 offset:1672
    v_mfma_f32_16x16x32_bf16 v[64:67], v[40:43], v[160:163], v[64:67]
    v_mfma_f32_16x16x32_bf16 v[68:71], v[40:43], v[128:131], v[68:71]
    v_mfma_f32_16x16x32_bf16 v[72:75], v[40:43], v[224:227], v[72:75]
    v_mfma_f32_16x16x32_bf16 v[76:79], v[40:43], v[192:195], v[76:79]
    s_waitcnt lgkmcnt(12)
    ds_read_b64 v[108:109], v56 offset:1728
    ds_read_b64 v[110:111], v56 offset:1736
    v_mfma_f32_16x16x32_bf16 v[64:67], v[44:47], v[164:167], v[64:67]
    v_mfma_f32_16x16x32_bf16 v[68:71], v[44:47], v[132:135], v[68:71]
    v_mfma_f32_16x16x32_bf16 v[72:75], v[44:47], v[228:231], v[72:75]
    v_mfma_f32_16x16x32_bf16 v[76:79], v[44:47], v[196:199], v[76:79]
    s_waitcnt lgkmcnt(11)
    ds_read_b64 v[40:41], v56 offset:1792
    ds_read_b64 v[42:43], v56 offset:1800
    v_mfma_f32_16x16x32_bf16 v[64:67], v[48:51], v[168:171], v[64:67]
    v_mfma_f32_16x16x32_bf16 v[68:71], v[48:51], v[136:139], v[68:71]
    v_mfma_f32_16x16x32_bf16 v[72:75], v[48:51], v[232:235], v[72:75]
    v_mfma_f32_16x16x32_bf16 v[76:79], v[48:51], v[200:203], v[76:79]
    s_waitcnt lgkmcnt(10)
    ds_read_b64 v[44:45], v56 offset:1856
    ds_read_b64 v[46:47], v56 offset:1864
    v_mfma_f32_16x16x32_bf16 v[64:67], v[52:55], v[172:175], v[64:67]
    v_mfma_f32_16x16x32_bf16 v[68:71], v[52:55], v[140:143], v[68:71]
    v_mfma_f32_16x16x32_bf16 v[72:75], v[52:55], v[236:239], v[72:75]
    v_mfma_f32_16x16x32_bf16 v[76:79], v[52:55], v[204:207], v[76:79]
    s_waitcnt lgkmcnt(10)
    ds_read_b64 v[48:49], v56 offset:1920
    ds_read_b64 v[50:51], v56 offset:1928
    v_mfma_f32_16x16x32_bf16 v[68:71], v[96:99], v[144:147], v[68:71]
    v_mfma_f32_16x16x32_bf16 v[72:75], v[96:99], v[112:115], v[72:75]
    v_mfma_f32_16x16x32_bf16 v[76:79], v[96:99], v[208:211], v[76:79]
    s_waitcnt lgkmcnt(10)
    ds_read_b64 v[52:53], v56 offset:1984
    ds_read_b64 v[54:55], v56 offset:1992
    v_mfma_f32_16x16x32_bf16 v[68:71], v[100:103], v[148:151], v[68:71]
    v_mfma_f32_16x16x32_bf16 v[72:75], v[100:103], v[116:119], v[72:75]
    v_mfma_f32_16x16x32_bf16 v[76:79], v[100:103], v[212:215], v[76:79]
    s_waitcnt lgkmcnt(10)
    ds_read_b64 v[96:97], v56 offset:2048
    ds_read_b64 v[98:99], v56 offset:2056
    v_mfma_f32_16x16x32_bf16 v[68:71], v[104:107], v[152:155], v[68:71]
    v_mfma_f32_16x16x32_bf16 v[72:75], v[104:107], v[120:123], v[72:75]
    v_mfma_f32_16x16x32_bf16 v[76:79], v[104:107], v[216:219], v[76:79]
    s_waitcnt lgkmcnt(10)
    ds_read_b64 v[100:101], v56 offset:2112
    ds_read_b64 v[102:103], v56 offset:2120
    v_mfma_f32_16x16x32_bf16 v[68:71], v[108:111], v[156:159], v[68:71]
    v_mfma_f32_16x16x32_bf16 v[72:75], v[108:111], v[124:127], v[72:75]
    v_mfma_f32_16x16x32_bf16 v[76:79], v[108:111], v[220:223], v[76:79]
    s_waitcnt lgkmcnt(10)
    ds_read_b64 v[104:105], v56 offset:2176
    ds_read_b64 v[106:107], v56 offset:2184
    v_mfma_f32_16x16x32_bf16 v[68:71], v[40:43], v[160:163], v[68:71]
    v_mfma_f32_16x16x32_bf16 v[72:75], v[40:43], v[128:131], v[72:75]
    v_mfma_f32_16x16x32_bf16 v[76:79], v[40:43], v[224:227], v[76:79]
    s_waitcnt lgkmcnt(10)
    ds_read_b64 v[108:109], v56 offset:2240
    ds_read_b64 v[110:111], v56 offset:2248
    v_mfma_f32_16x16x32_bf16 v[68:71], v[44:47], v[164:167], v[68:71]
    v_mfma_f32_16x16x32_bf16 v[72:75], v[44:47], v[132:135], v[72:75]
    v_mfma_f32_16x16x32_bf16 v[76:79], v[44:47], v[228:231], v[76:79]
    s_waitcnt lgkmcnt(10)
    ds_read_b64 v[40:41], v56 offset:2304
    ds_read_b64 v[42:43], v56 offset:2312
    v_mfma_f32_16x16x32_bf16 v[68:71], v[48:51], v[168:171], v[68:71]
    v_mfma_f32_16x16x32_bf16 v[72:75], v[48:51], v[136:139], v[72:75]
    v_mfma_f32_16x16x32_bf16 v[76:79], v[48:51], v[232:235], v[76:79]
    s_waitcnt lgkmcnt(10)
    ds_read_b64 v[44:45], v56 offset:2368
    ds_read_b64 v[46:47], v56 offset:2376
    v_mfma_f32_16x16x32_bf16 v[68:71], v[52:55], v[172:175], v[68:71]
    v_mfma_f32_16x16x32_bf16 v[72:75], v[52:55], v[140:143], v[72:75]
    v_mfma_f32_16x16x32_bf16 v[76:79], v[52:55], v[236:239], v[76:79]
    buffer_load_dword v59, v58, s[16:19], 0 offen offset:8 sc1
    s_waitcnt lgkmcnt(10)
    ds_read_b64 v[48:49], v56 offset:2432
    ds_read_b64 v[50:51], v56 offset:2440
    v_mfma_f32_16x16x32_bf16 v[72:75], v[96:99], v[144:147], v[72:75]
    v_mfma_f32_16x16x32_bf16 v[76:79], v[96:99], v[112:115], v[76:79]
    s_waitcnt lgkmcnt(10)
    ds_read_b64 v[52:53], v56 offset:2496
    ds_read_b64 v[54:55], v56 offset:2504
    v_mfma_f32_16x16x32_bf16 v[72:75], v[100:103], v[148:151], v[72:75]
    v_mfma_f32_16x16x32_bf16 v[76:79], v[100:103], v[116:119], v[76:79]
    s_waitcnt lgkmcnt(10)
    ds_read_b64 v[96:97], v56 offset:2560
    ds_read_b64 v[98:99], v56 offset:2568
    v_mfma_f32_16x16x32_bf16 v[72:75], v[104:107], v[152:155], v[72:75]
    v_mfma_f32_16x16x32_bf16 v[76:79], v[104:107], v[120:123], v[76:79]
    s_waitcnt lgkmcnt(10)
    ds_read_b64 v[100:101], v56 offset:2624
    ds_read_b64 v[102:103], v56 offset:2632
    v_mfma_f32_16x16x32_bf16 v[72:75], v[108:111], v[156:159], v[72:75]
    v_mfma_f32_16x16x32_bf16 v[76:79], v[108:111], v[124:127], v[76:79]
    s_waitcnt lgkmcnt(10)
    ds_read_b64 v[104:105], v56 offset:2688
    ds_read_b64 v[106:107], v56 offset:2696
    v_mfma_f32_16x16x32_bf16 v[72:75], v[40:43], v[160:163], v[72:75]
    v_mfma_f32_16x16x32_bf16 v[76:79], v[40:43], v[128:131], v[76:79]
    s_waitcnt lgkmcnt(10)
    ds_read_b64 v[108:109], v56 offset:2752
    ds_read_b64 v[110:111], v56 offset:2760
    v_mfma_f32_16x16x32_bf16 v[72:75], v[44:47], v[164:167], v[72:75]
    v_mfma_f32_16x16x32_bf16 v[76:79], v[44:47], v[132:135], v[76:79]
    s_waitcnt lgkmcnt(10)
    ds_read_b64 v[40:41], v56 offset:2816
    ds_read_b64 v[42:43], v56 offset:2824
    v_mfma_f32_16x16x32_bf16 v[72:75], v[48:51], v[168:171], v[72:75]
    v_mfma_f32_16x16x32_bf16 v[76:79], v[48:51], v[136:139], v[76:79]
    s_waitcnt lgkmcnt(10)
    ds_read_b64 v[44:45], v56 offset:2880
    ds_read_b64 v[46:47], v56 offset:2888
    v_mfma_f32_16x16x32_bf16 v[72:75], v[52:55], v[172:175], v[72:75]
    v_mfma_f32_16x16x32_bf16 v[76:79], v[52:55], v[140:143], v[76:79]
    s_waitcnt lgkmcnt(10)
    ds_read_b64 v[48:49], v56 offset:2944
    ds_read_b64 v[50:51], v56 offset:2952
    v_mfma_f32_16x16x32_bf16 v[76:79], v[96:99], v[144:147], v[76:79]
    s_waitcnt lgkmcnt(10)
    ds_read_b64 v[52:53], v56 offset:3008
    ds_read_b64 v[54:55], v56 offset:3016
    v_mfma_f32_16x16x32_bf16 v[76:79], v[100:103], v[148:151], v[76:79]
    s_waitcnt lgkmcnt(10)
    v_mfma_f32_16x16x32_bf16 v[76:79], v[104:107], v[152:155], v[76:79]
    s_waitcnt lgkmcnt(8)
    v_mfma_f32_16x16x32_bf16 v[76:79], v[108:111], v[156:159], v[76:79]
    s_waitcnt lgkmcnt(6)
    v_mfma_f32_16x16x32_bf16 v[76:79], v[40:43], v[160:163], v[76:79]
    s_waitcnt lgkmcnt(4)
    v_mfma_f32_16x16x32_bf16 v[76:79], v[44:47], v[164:167], v[76:79]
    s_waitcnt lgkmcnt(2)
    v_mfma_f32_16x16x32_bf16 v[76:79], v[48:51], v[168:171], v[76:79]
    s_waitcnt lgkmcnt(0)
    v_mfma_f32_16x16x32_bf16 v[76:79], v[52:55], v[172:175], v[76:79]
    ds_read_b64 v[96:97], v60 offset:512
    ds_read_b64 v[98:99], v60 offset:768
    ds_read_b64 v[100:101], v60 offset:1024
    ds_read_b64 v[102:103], v60 offset:1280
    s_lshl_b32 s62, s88, 16
    s_and_b32 s63, s88, 0xffff0000
    s_cmp_eq_u32 s89, 0
    s_cselect_b32 s62, s62, s63
    s_waitcnt lgkmcnt(0)
    v_lshlrev_b32 v115, 16, v96
    v_and_b32 v114, 0xffff0000, v96
    v_lshlrev_b32 v113, 16, v97
    v_and_b32 v112, 0xffff0000, v97
    v_lshlrev_b32 v119, 16, v98
    v_and_b32 v118, 0xffff0000, v98
    v_lshlrev_b32 v117, 16, v99
    v_and_b32 v116, 0xffff0000, v99
    v_lshlrev_b32 v123, 16, v100
    v_and_b32 v122, 0xffff0000, v100
    v_lshlrev_b32 v121, 16, v101
    v_and_b32 v120, 0xffff0000, v101
    v_lshlrev_b32 v127, 16, v102
    v_and_b32 v126, 0xffff0000, v102
    v_lshlrev_b32 v125, 16, v103
    v_and_b32 v124, 0xffff0000, v103
    v_fmac_f32 v64, s62, v112
    v_fmac_f32 v65, s62, v113
    v_fmac_f32 v66, s62, v114
    v_fmac_f32 v67, s62, v115
    v_fmac_f32 v68, s62, v116
    v_fmac_f32 v69, s62, v117
    v_fmac_f32 v70, s62, v118
    v_fmac_f32 v71, s62, v119
    v_fmac_f32 v72, s62, v120
    v_fmac_f32 v73, s62, v121
    v_fmac_f32 v74, s62, v122
    v_fmac_f32 v75, s62, v123
    v_fmac_f32 v76, s62, v124
    v_fmac_f32 v77, s62, v125
    v_fmac_f32 v78, s62, v126
    v_fmac_f32 v79, s62, v127
    v_cvt_pk_bf16_f32 v96, v64, v65
    v_cvt_pk_bf16_f32 v97, v66, v67
    v_cvt_pk_bf16_f32 v98, v68, v69
    v_cvt_pk_bf16_f32 v99, v70, v71
    v_cvt_pk_bf16_f32 v100, v72, v73
    v_cvt_pk_bf16_f32 v101, v74, v75
    v_cvt_pk_bf16_f32 v102, v76, v77
    v_cvt_pk_bf16_f32 v103, v78, v79
    v_min_u32 v96, -2, v96
    v_min_u32 v97, -2, v97
    v_min_u32 v98, -2, v98
    v_min_u32 v99, -2, v99
    v_min_u32 v100, -2, v100
    v_min_u32 v101, -2, v101
    v_min_u32 v102, -2, v102
    v_min_u32 v103, -2, v103
    ds_write_b64 v61, v[96:97] offset:1024
    ds_write_b64 v61, v[98:99] offset:1536
    ds_write_b64 v61, v[100:101] offset:2048
    ds_write_b64 v61, v[102:103] offset:2560
    s_waitcnt lgkmcnt(0)
CV_JOIN:
    s_barrier
    ds_read_b128 v[96:99], v62
    ds_read_b128 v[100:103], v62 offset:512
    s_mov_b32 s82, 0x300000
    s_waitcnt lgkmcnt(1)
    buffer_store_dwordx4 v[96:99], v63, s[16:19], s82 offen sc1
    s_waitcnt lgkmcnt(0)
    buffer_store_dwordx4 v[100:103], v63, s[16:19], s82 offen offset:1024 sc1
    s_waitcnt vmcnt(11)
    s_mov_b32 s62, 0x3f803f80
    v_dot2_f32_bf16 v208, v8, s62, 0
    v_dot2_f32_bf16 v209, v8, v8, 0
    v_dot2_f32_bf16 v210, v9, s62, 0
    v_dot2_f32_bf16 v211, v9, v9, 0
    v_dot2_f32_bf16 v212, v10, s62, 0
    v_dot2_f32_bf16 v213, v10, v10, 0
    v_dot2_f32_bf16 v214, v11, s62, 0
    v_dot2_f32_bf16 v215, v11, v11, 0
    v_dot2_f32_bf16 v216, v12, s62, 0
    v_dot2_f32_bf16 v217, v12, v12, 0
    v_dot2_f32_bf16 v218, v13, s62, 0
    v_dot2_f32_bf16 v219, v13, v13, 0
    v_dot2_f32_bf16 v220, v14, s62, 0
    v_dot2_f32_bf16 v221, v14, v14, 0
    v_dot2_f32_bf16 v222, v15, s62, 0
    v_dot2_f32_bf16 v223, v15, v15, 0
    s_nop 2
    v_permlane32_swap_b32 v208, v209
    v_permlane32_swap_b32 v210, v211
    v_permlane32_swap_b32 v212, v213
    v_permlane32_swap_b32 v214, v215
    v_permlane32_swap_b32 v216, v217
    v_permlane32_swap_b32 v218, v219
    v_permlane32_swap_b32 v220, v221
    v_permlane32_swap_b32 v222, v223
    v_add_f32 v208, v208, v209
    v_add_f32 v210, v210, v211
    v_add_f32 v212, v212, v213
    v_add_f32 v214, v214, v215
    v_add_f32 v216, v216, v217
    v_add_f32 v218, v218, v219
    v_add_f32 v220, v220, v221
    v_add_f32 v222, v222, v223
    v_permlane16_swap_b32 v208, v210
    v_permlane16_swap_b32 v212, v214
    v_permlane16_swap_b32 v216, v218
    v_permlane16_swap_b32 v220, v222
    v_add_f32 v208, v208, v210
    v_add_f32 v212, v212, v214
    v_add_f32 v216, v216, v218
    v_add_f32 v220, v220, v222
    v_add_f32_dpp v208, v208, v208 row_ror:8 row_mask:0xf bank_mask:0xf
    v_add_f32_dpp v212, v212, v212 row_ror:8 row_mask:0xf bank_mask:0xf
    v_add_f32_dpp v216, v216, v216 row_ror:8 row_mask:0xf bank_mask:0xf
    v_add_f32_dpp v220, v220, v220 row_ror:8 row_mask:0xf bank_mask:0xf
    v_add_f32_dpp v208, v208, v208 row_ror:4 row_mask:0xf bank_mask:0xf
    v_add_f32_dpp v212, v212, v212 row_ror:4 row_mask:0xf bank_mask:0xf
    v_add_f32_dpp v216, v216, v216 row_ror:4 row_mask:0xf bank_mask:0xf
    v_add_f32_dpp v220, v220, v220 row_ror:4 row_mask:0xf bank_mask:0xf
    v_add_f32_dpp v208, v208, v208 row_ror:2 row_mask:0xf bank_mask:0xf
    v_add_f32_dpp v212, v212, v212 row_ror:2 row_mask:0xf bank_mask:0xf
    v_add_f32_dpp v216, v216, v216 row_ror:2 row_mask:0xf bank_mask:0xf
    v_add_f32_dpp v220, v220, v220 row_ror:2 row_mask:0xf bank_mask:0xf
    v_add_f32_dpp v208, v208, v208 row_ror:1 row_mask:0xf bank_mask:0xf
    v_add_f32_dpp v212, v212, v212 row_ror:1 row_mask:0xf bank_mask:0xf
    v_add_f32_dpp v216, v216, v216 row_ror:1 row_mask:0xf bank_mask:0xf
    v_add_f32_dpp v220, v220, v220 row_ror:1 row_mask:0xf bank_mask:0xf
    s_mov_b32 exec_lo, 0x00010001
    s_mov_b32 exec_hi, 0x00010001
    ds_write_b32 v243, v208 offset:46080
    ds_write_b32 v243, v212 offset:46144
    ds_write_b32 v243, v216 offset:46208
    ds_write_b32 v243, v220 offset:46272
    s_mov_b64 exec, -1
    s_mov_b32 s62, 0x3b124925
    s_mov_b32 s63, 0x3727c5ac
    s_waitcnt lgkmcnt(0)
    s_barrier
    ds_read_b128 v[208:211], v244 offset:46080
    ds_read_b128 v[212:215], v244 offset:46096
    s_waitcnt lgkmcnt(0)
    v_add_f32 v208, v208, v209
    v_add_f32 v212, v212, v213
    v_add_f32 v210, v210, v211
    v_add_f32 v214, v214, v215
    v_add_f32 v208, v208, v210
    v_add_f32 v212, v212, v214
    v_mul_f32 v208, s62, v208
    v_mul_f32 v212, s62, v212
    v_fma_f32 v212, -v208, v208, v212
    v_max_f32 v212, 0, v212
    v_add_f32 v213, s63, v212
    v_rsq_f32 v213, v213
    s_nop 0
    v_readlane_b32 s64, v208, 0
    v_readlane_b32 s65, v213, 0
    v_readlane_b32 s66, v208, 1
    v_readlane_b32 s67, v213, 1
    v_readlane_b32 s68, v208, 2
    v_readlane_b32 s69, v213, 2
    v_readlane_b32 s70, v208, 3
    v_readlane_b32 s71, v213, 3
    v_readlane_b32 s72, v208, 4
    v_readlane_b32 s73, v213, 4
    v_readlane_b32 s74, v208, 5
    v_readlane_b32 s75, v213, 5
    v_readlane_b32 s76, v208, 6
    v_readlane_b32 s77, v213, 6
    v_readlane_b32 s78, v208, 7
    v_readlane_b32 s79, v213, 7
    v_lshlrev_b32 v208, 16, v8
    v_and_b32 v209, 0xffff0000, v8
    v_lshlrev_b32 v210, 16, v9
    v_and_b32 v211, 0xffff0000, v9
    v_lshlrev_b32 v212, 16, v10
    v_and_b32 v213, 0xffff0000, v10
    v_lshlrev_b32 v214, 16, v11
    v_and_b32 v215, 0xffff0000, v11
    v_lshlrev_b32 v216, 16, v12
    v_and_b32 v217, 0xffff0000, v12
    v_lshlrev_b32 v218, 16, v13
    v_and_b32 v219, 0xffff0000, v13
    v_lshlrev_b32 v220, 16, v14
    v_and_b32 v221, 0xffff0000, v14
    v_lshlrev_b32 v222, 16, v15
    v_and_b32 v223, 0xffff0000, v15
    v_pk_add_f32 v[192:193], v[208:209], s[64:65] op_sel_hi:[1,0] neg_lo:[0,1] neg_hi:[0,1]
    v_pk_add_f32 v[194:195], v[210:211], s[66:67] op_sel_hi:[1,0] neg_lo:[0,1] neg_hi:[0,1]
    v_pk_add_f32 v[196:197], v[212:213], s[68:69] op_sel_hi:[1,0] neg_lo:[0,1] neg_hi:[0,1]
    v_pk_add_f32 v[198:199], v[214:215], s[70:71] op_sel_hi:[1,0] neg_lo:[0,1] neg_hi:[0,1]
    v_pk_add_f32 v[200:201], v[216:217], s[72:73] op_sel_hi:[1,0] neg_lo:[0,1] neg_hi:[0,1]
    v_pk_add_f32 v[202:203], v[218:219], s[74:75] op_sel_hi:[1,0] neg_lo:[0,1] neg_hi:[0,1]
    v_pk_add_f32 v[204:205], v[220:221], s[76:77] op_sel_hi:[1,0] neg_lo:[0,1] neg_hi:[0,1]
    v_pk_add_f32 v[206:207], v[222:223], s[78:79] op_sel_hi:[1,0] neg_lo:[0,1] neg_hi:[0,1]
    v_pk_mul_f32 v[192:193], v[192:193], s[64:65] op_sel:[0,1] op_sel_hi:[1,1]
    v_pk_mul_f32 v[194:195], v[194:195], s[66:67] op_sel:[0,1] op_sel_hi:[1,1]
    v_pk_mul_f32 v[196:197], v[196:197], s[68:69] op_sel:[0,1] op_sel_hi:[1,1]
    v_pk_mul_f32 v[198:199], v[198:199], s[70:71] op_sel:[0,1] op_sel_hi:[1,1]
    v_pk_mul_f32 v[200:201], v[200:201], s[72:73] op_sel:[0,1] op_sel_hi:[1,1]
    v_pk_mul_f32 v[202:203], v[202:203], s[74:75] op_sel:[0,1] op_sel_hi:[1,1]
    v_pk_mul_f32 v[204:205], v[204:205], s[76:77] op_sel:[0,1] op_sel_hi:[1,1]
    v_pk_mul_f32 v[206:207], v[206:207], s[78:79] op_sel:[0,1] op_sel_hi:[1,1]
    s_add_u32 m0, s61, 32768
    s_add_u32 s92, s92, 57344
    s_cmp_eq_u32 s92, 0x1c0000
    s_cselect_b32 s92, 0x0, s92
    buffer_load_dwordx4 v24, s[20:23], s92 offen lds
    buffer_load_dwordx4 v25, s[20:23], s92 offen offset:1024 lds
    s_add_u32 m0, s61, 40960
    s_add_u32 s92, s92, 57344
    s_cmp_eq_u32 s92, 0x1c0000
    s_cselect_b32 s92, 0x0, s92
    buffer_load_dwordx4 v24, s[20:23], s92 offen lds
    buffer_load_dwordx4 v25, s[20:23], s92 offen offset:1024 lds
    s_waitcnt vmcnt(13)
    ds_read_b64_tr_b16 a[0:1], v28 offset:0
    ds_read_b64_tr_b16 a[2:3], v28 offset:512
    ds_read_b64_tr_b16 a[4:5], v29 offset:0
    ds_read_b64_tr_b16 a[6:7], v29 offset:512
    s_add_u32 m0, s61, 49152
    s_add_u32 s92, s92, 57344
    s_cmp_eq_u32 s92, 0x1c0000
    s_cselect_b32 s92, 0x0, s92
    buffer_load_dwordx4 v24, s[20:23], s92 offen lds
    buffer_load_dwordx4 v25, s[20:23], s92 offen offset:1024 lds
    s_waitcnt vmcnt(13)
    ds_read_b64_tr_b16 a[8:9], v28 offset:8192
    ds_read_b64_tr_b16 a[10:11], v28 offset:8704
    ds_read_b64_tr_b16 a[12:13], v29 offset:8192
    ds_read_b64_tr_b16 a[14:15], v29 offset:8704
    s_add_u32 m0, s61, 57344
    s_add_u32 s92, s92, 57344
    s_cmp_eq_u32 s92, 0x1c0000
    s_cselect_b32 s92, 0x0, s92
    buffer_load_dwordx4 v24, s[20:23], s92 offen lds
    buffer_load_dwordx4 v25, s[20:23], s92 offen offset:1024 lds
    s_waitcnt vmcnt(13)
    ds_read_b64_tr_b16 a[16:17], v28 offset:16384
    ds_read_b64_tr_b16 a[18:19], v28 offset:16896
    ds_read_b64_tr_b16 a[20:21], v29 offset:16384
    ds_read_b64_tr_b16 a[22:23], v29 offset:16896
    s_add_u32 m0, s61, 65536
    s_add_u32 s92, s92, 57344
    s_cmp_eq_u32 s92, 0x1c0000
    s_cselect_b32 s92, 0x0, s92
    buffer_load_dwordx4 v24, s[20:23], s92 offen lds
    buffer_load_dwordx4 v25, s[20:23], s92 offen offset:1024 lds
    s_waitcnt vmcnt(13)
    ds_read_b64_tr_b16 a[24:25], v28 offset:24576
    ds_read_b64_tr_b16 a[26:27], v28 offset:25088
    ds_read_b64_tr_b16 a[28:29], v29 offset:24576
    ds_read_b64_tr_b16 a[30:31], v29 offset:25088
    s_add_u32 m0, s61, 73728
    s_add_u32 s92, s92, 57344
    s_cmp_eq_u32 s92, 0x1c0000
    s_cselect_b32 s92, 0x0, s92
    buffer_load_dwordx4 v24, s[20:23], s92 offen lds
    buffer_load_dwordx4 v25, s[20:23], s92 offen offset:1024 lds
    s_waitcnt vmcnt(10)
    ds_read_b64_tr_b16 a[32:33], v28 offset:32768
    ds_read_b64_tr_b16 a[34:35], v28 offset:33280
    ds_read_b64_tr_b16 a[36:37], v29 offset:32768
    ds_read_b64_tr_b16 a[38:39], v29 offset:33280
    s_add_u32 m0, s61, 81920
    s_add_u32 s92, s92, 57344
    s_cmp_eq_u32 s92, 0x1c0000
    s_cselect_b32 s92, 0x0, s92
    buffer_load_dwordx4 v24, s[20:23], s92 offen lds
    buffer_load_dwordx4 v25, s[20:23], s92 offen offset:1024 lds
    s_waitcnt vmcnt(10)
    ds_read_b64_tr_b16 a[40:41], v28 offset:40960
    ds_read_b64_tr_b16 a[42:43], v28 offset:41472
    ds_read_b64_tr_b16 a[44:45], v29 offset:40960
    ds_read_b64_tr_b16 a[46:47], v29 offset:41472
    s_add_u32 m0, s61, 90112
    s_add_u32 s92, s92, 57344
    s_cmp_eq_u32 s92, 0x1c0000
    s_cselect_b32 s92, 0x0, s92
    buffer_load_dwordx4 v24, s[20:23], s92 offen lds
    buffer_load_dwordx4 v25, s[20:23], s92 offen offset:1024 lds
    s_waitcnt vmcnt(10)
    ds_read_b64_tr_b16 a[48:49], v28 offset:49152
    ds_read_b64_tr_b16 a[50:51], v28 offset:49664
    ds_read_b64_tr_b16 a[52:53], v29 offset:49152
    ds_read_b64_tr_b16 a[54:55], v29 offset:49664
    s_add_u32 m0, s61, 98304
    s_add_u32 s92, s92, 57344
    s_cmp_eq_u32 s92, 0x1c0000
    s_cselect_b32 s92, 0x0, s92
    buffer_load_dwordx4 v24, s[20:23], s92 offen lds
    buffer_load_dwordx4 v25, s[20:23], s92 offen offset:1024 lds
    s_waitcnt vmcnt(10)
    ds_read_b64_tr_b16 a[56:57], v30 offset:0
    ds_read_b64_tr_b16 a[58:59], v30 offset:512
    ds_read_b64_tr_b16 a[60:61], v31 offset:0
    ds_read_b64_tr_b16 a[62:63], v31 offset:512
    s_add_u32 m0, s61, 106496
    s_add_u32 s92, s92, 57344
    s_cmp_eq_u32 s92, 0x1c0000
    s_cselect_b32 s92, 0x0, s92
    buffer_load_dwordx4 v24, s[20:23], s92 offen lds
    buffer_load_dwordx4 v25, s[20:23], s92 offen offset:1024 lds
    s_waitcnt vmcnt(10)
    ds_read_b64_tr_b16 a[64:65], v30 offset:8192
    ds_read_b64_tr_b16 a[66:67], v30 offset:8704
    ds_read_b64_tr_b16 a[68:69], v31 offset:8192
    ds_read_b64_tr_b16 a[70:71], v31 offset:8704
    s_waitcnt lgkmcnt(0)
    s_add_u32 m0, s61, 0
    s_add_u32 s92, s92, 57344
    s_cmp_eq_u32 s92, 0x1c0000
    s_cselect_b32 s92, 0x0, s92
    buffer_load_dwordx4 v24, s[20:23], s92 offen lds
    buffer_load_dwordx4 v25, s[20:23], s92 offen offset:1024 lds
    s_waitcnt vmcnt(10)
    ds_read_b64_tr_b16 a[72:73], v30 offset:16384
    ds_read_b64_tr_b16 a[74:75], v30 offset:16896
    ds_read_b64_tr_b16 a[76:77], v31 offset:16384
    ds_read_b64_tr_b16 a[78:79], v31 offset:16896
    s_add_u32 m0, s61, 8192
    s_add_u32 s92, s92, 57344
    s_cmp_eq_u32 s92, 0x1c0000
    s_cselect_b32 s92, 0x0, s92
    buffer_load_dwordx4 v24, s[20:23], s92 offen lds
    buffer_load_dwordx4 v25, s[20:23], s92 offen offset:1024 lds
    s_waitcnt vmcnt(10)
    ds_read_b64_tr_b16 a[80:81], v30 offset:24576
    ds_read_b64_tr_b16 a[82:83], v30 offset:25088
    ds_read_b64_tr_b16 a[84:85], v31 offset:24576
    ds_read_b64_tr_b16 a[86:87], v31 offset:25088
    s_add_u32 m0, s61, 16384
    s_add_u32 s92, s92, 57344
    s_cmp_eq_u32 s92, 0x1c0000
    s_cselect_b32 s92, 0x0, s92
    buffer_load_dwordx4 v24, s[20:23], s92 offen lds
    buffer_load_dwordx4 v25, s[20:23], s92 offen offset:1024 lds
    s_mov_b32 s80, 0
    s_branch CB_5_chk
CB_5:
    buffer_load_dword v59, v58, s[16:19], 0 offen offset:8 sc1
    s_waitcnt vmcnt(0)
CB_5_chk:
    v_cmp_le_i32 vcc, 0, v58
    v_mov_b32 v60, s3
    s_nop 0
    v_cndmask_b32 v59, v60, v59, vcc
    v_cmp_ne_u32 vcc, s3, v59
    s_cbranch_vccz CB_5_ok
    s_add_u32 s80, s80, 1
    s_cmp_gt_u32 s80, 40000
    s_cbranch_scc1 CB_5_ok
    s_sleep 2
    s_branch CB_5
CB_5_ok:
    s_mov_b32 s81, 0x300000
    buffer_load_dwordx4 v[48:51], v36, s[16:19], s81 offen sc1
    buffer_load_dwordx4 v[52:55], v241, s[16:19], s81 offen sc1
    s_waitcnt vmcnt(12)
    ds_read_b64_tr_b16 a[88:89], v30 offset:32768
    ds_read_b64_tr_b16 a[90:91], v30 offset:33280
    ds_read_b64_tr_b16 a[92:93], v31 offset:32768
    ds_read_b64_tr_b16 a[94:95], v31 offset:33280
    s_add_u32 m0, s61, 24576
    s_add_u32 s92, s92, 57344
    s_cmp_eq_u32 s92, 0x1c0000
    s_cselect_b32 s92, 0x0, s92
    buffer_load_dwordx4 v24, s[20:23], s92 offen lds
    buffer_load_dwordx4 v25, s[20:23], s92 offen offset:1024 lds
    s_waitcnt vmcnt(12)
    ds_read_b64_tr_b16 a[96:97], v30 offset:40960
    ds_read_b64_tr_b16 a[98:99], v30 offset:41472
    ds_read_b64_tr_b16 a[100:101], v31 offset:40960
    ds_read_b64_tr_b16 a[102:103], v31 offset:41472
    s_add_u32 m0, s61, 32768
    s_add_u32 s92, s92, 57344
    s_cmp_eq_u32 s92, 0x1c0000
    s_cselect_b32 s92, 0x0, s92
    buffer_load_dwordx4 v24, s[20:23], s92 offen lds
    buffer_load_dwordx4 v25, s[20:23], s92 offen offset:1024 lds
    s_waitcnt vmcnt(12)
    ds_read_b64_tr_b16 a[104:105], v30 offset:49152
    ds_read_b64_tr_b16 a[106:107], v30 offset:49664
    ds_read_b64_tr_b16 a[108:109], v31 offset:49152
    ds_read_b64_tr_b16 a[110:111], v31 offset:49664
    s_add_u32 m0, s61, 40960
    s_add_u32 s92, s92, 57344
    s_cmp_eq_u32 s92, 0x1c0000
    s_cselect_b32 s92, 0x0, s92
    buffer_load_dwordx4 v24, s[20:23], s92 offen lds
    buffer_load_dwordx4 v25, s[20:23], s92 offen offset:1024 lds
    s_waitcnt vmcnt(12)
    ds_read_b64_tr_b16 a[112:113], v28 offset:0
    ds_read_b64_tr_b16 a[114:115], v28 offset:512
    ds_read_b64_tr_b16 a[116:117], v29 offset:0
    ds_read_b64_tr_b16 a[118:119], v29 offset:512
    s_add_u32 m0, s61, 49152
    s_add_u32 s92, s92, 57344
    s_cmp_eq_u32 s92, 0x1c0000
    s_cselect_b32 s92, 0x0, s92
    buffer_load_dwordx4 v24, s[20:23], s92 offen lds
    buffer_load_dwordx4 v25, s[20:23], s92 offen offset:1024 lds
    s_waitcnt vmcnt(12)
    ds_read_b64_tr_b16 a[120:121], v28 offset:8192
    ds_read_b64_tr_b16 a[122:123], v28 offset:8704
    ds_read_b64_tr_b16 a[124:125], v29 offset:8192
    ds_read_b64_tr_b16 a[126:127], v29 offset:8704
    s_add_u32 m0, s61, 57344
    s_add_u32 s92, s92, 57344
    s_cmp_eq_u32 s92, 0x1c0000
    s_cselect_b32 s92, 0x0, s92
    buffer_load_dwordx4 v24, s[20:23], s92 offen lds
    buffer_load_dwordx4 v25, s[20:23], s92 offen offset:1024 lds
    s_mov_b32 s80, 0
    s_waitcnt vmcnt(10)
    s_branch PY_6_chk
PY_6:
    s_mov_b32 s81, 0x300000
    buffer_load_dwordx4 v[48:51], v36, s[16:19], s81 offen sc1
    buffer_load_dwordx4 v[52:55], v241, s[16:19], s81 offen sc1
    s_waitcnt vmcnt(0)
PY_6_chk:
    v_max3_u32 v56, v48, v49, v50
    v_max3_u32 v57, v51, v52, v53
    v_max3_u32 v56, v56, v54, v55
    v_max_u32 v56, v56, v57
    v_cmp_eq_u32 vcc, -1, v56
    s_cbranch_vccz PY_6_ok
    s_add_u32 s80, s80, 1
    s_cmp_gt_u32 s80, 40000
    s_cbranch_scc1 PY_6_ok
    s_sleep 2
    s_branch PY_6
PY_6_ok:
    s_mov_b32 vcc_lo, 0x55555555
    s_mov_b32 vcc_hi, 0x55555555
    v_cndmask_b32_dpp v40, v52, v48, vcc quad_perm:[1,0,3,2] row_mask:0xf bank_mask:0xf
    v_cndmask_b32_dpp v41, v53, v49, vcc quad_perm:[1,0,3,2] row_mask:0xf bank_mask:0xf
    v_cndmask_b32_dpp v42, v54, v50, vcc quad_perm:[1,0,3,2] row_mask:0xf bank_mask:0xf
    v_cndmask_b32_dpp v43, v55, v51, vcc quad_perm:[1,0,3,2] row_mask:0xf bank_mask:0xf
    s_mov_b32 vcc_lo, 0xaaaaaaaa
    s_mov_b32 vcc_hi, 0xaaaaaaaa
    v_cndmask_b32_dpp v44, v48, v52, vcc quad_perm:[1,0,3,2] row_mask:0xf bank_mask:0xf
    v_cndmask_b32_dpp v45, v49, v53, vcc quad_perm:[1,0,3,2] row_mask:0xf bank_mask:0xf
    v_cndmask_b32_dpp v46, v50, v54, vcc quad_perm:[1,0,3,2] row_mask:0xf bank_mask:0xf
    v_cndmask_b32_dpp v47, v51, v55, vcc quad_perm:[1,0,3,2] row_mask:0xf bank_mask:0xf
    v_lshlrev_b32 v224, 16, v40
    v_and_b32 v226, 0xffff0000, v40
    v_lshlrev_b32 v228, 16, v41
    v_and_b32 v230, 0xffff0000, v41
    v_lshlrev_b32 v232, 16, v42
    v_and_b32 v234, 0xffff0000, v42
    v_lshlrev_b32 v236, 16, v43
    v_and_b32 v238, 0xffff0000, v43
    v_lshlrev_b32 v225, 16, v44
    v_and_b32 v227, 0xffff0000, v44
    v_lshlrev_b32 v229, 16, v45
    v_and_b32 v231, 0xffff0000, v45
    v_lshlrev_b32 v233, 16, v46
    v_and_b32 v235, 0xffff0000, v46
    v_lshlrev_b32 v237, 16, v47
    v_and_b32 v239, 0xffff0000, v47
    v_pk_fma_f32 v[208:209], v[192:193], v[224:225], v[208:209]
    v_pk_fma_f32 v[210:211], v[194:195], v[226:227], v[210:211]
    v_pk_fma_f32 v[212:213], v[196:197], v[228:229], v[212:213]
    v_pk_fma_f32 v[214:215], v[198:199], v[230:231], v[214:215]
    v_pk_fma_f32 v[216:217], v[200:201], v[232:233], v[216:217]
    v_pk_fma_f32 v[218:219], v[202:203], v[234:235], v[218:219]
    v_pk_fma_f32 v[220:221], v[204:205], v[236:237], v[220:221]
    v_pk_fma_f32 v[222:223], v[206:207], v[238:239], v[222:223]
    v_cvt_pk_bf16_f32 v8, v208, v209
    v_cvt_pk_bf16_f32 v9, v210, v211
    v_cvt_pk_bf16_f32 v10, v212, v213
    v_cvt_pk_bf16_f32 v11, v214, v215
    v_cvt_pk_bf16_f32 v12, v216, v217
    v_cvt_pk_bf16_f32 v13, v218, v219
    v_cvt_pk_bf16_f32 v14, v220, v221
    v_cvt_pk_bf16_f32 v15, v222, v223
    s_mov_b32 s62, 0x3f803f80
    v_dot2_f32_bf16 v224, v8, s62, 0
    v_dot2_f32_bf16 v225, v8, v8, 0
    v_dot2_f32_bf16 v226, v9, s62, 0
    v_dot2_f32_bf16 v227, v9, v9, 0
    v_dot2_f32_bf16 v228, v10, s62, 0
    v_dot2_f32_bf16 v229, v10, v10, 0
    v_dot2_f32_bf16 v230, v11, s62, 0
    v_dot2_f32_bf16 v231, v11, v11, 0
    v_dot2_f32_bf16 v232, v12, s62, 0
    v_dot2_f32_bf16 v233, v12, v12, 0
    v_dot2_f32_bf16 v234, v13, s62, 0
    v_dot2_f32_bf16 v235, v13, v13, 0
    v_dot2_f32_bf16 v236, v14, s62, 0
    v_dot2_f32_bf16 v237, v14, v14, 0
    v_dot2_f32_bf16 v238, v15, s62, 0
    v_dot2_f32_bf16 v239, v15, v15, 0
    s_nop 1
    v_permlane32_swap_b32 v224, v225
    v_permlane32_swap_b32 v226, v227
    v_permlane32_swap_b32 v228, v229
    v_permlane32_swap_b32 v230, v231
    v_permlane32_swap_b32 v232, v233
    v_permlane32_swap_b32 v234, v235
    v_permlane32_swap_b32 v236, v237
    v_permlane32_swap_b32 v238, v239
    v_add_f32 v224, v224, v225
    v_add_f32 v226, v226, v227
    v_add_f32 v228, v228, v229
    v_add_f32 v230, v230, v231
    v_add_f32 v232, v232, v233
    v_add_f32 v234, v234, v235
    v_add_f32 v236, v236, v237
    v_add_f32 v238, v238, v239
    v_permlane16_swap_b32 v224, v226
    v_permlane16_swap_b32 v228, v230
    v_permlane16_swap_b32 v232, v234
    v_permlane16_swap_b32 v236, v238
    v_add_f32 v224, v224, v226
    v_add_f32 v228, v228, v230
    v_add_f32 v232, v232, v234
    v_add_f32 v236, v236, v238
    v_add_f32_dpp v224, v224, v224 row_ror:8 row_mask:0xf bank_mask:0xf
    v_add_f32_dpp v228, v228, v228 row_ror:8 row_mask:0xf bank_mask:0xf
    v_add_f32_dpp v232, v232, v232 row_ror:8 row_mask:0xf bank_mask:0xf
    v_add_f32_dpp v236, v236, v236 row_ror:8 row_mask:0xf bank_mask:0xf
    v_add_f32_dpp v224, v224, v224 row_ror:4 row_mask:0xf bank_mask:0xf
    v_add_f32_dpp v228, v228, v228 row_ror:4 row_mask:0xf bank_mask:0xf
    v_add_f32_dpp v232, v232, v232 row_ror:4 row_mask:0xf bank_mask:0xf
    v_add_f32_dpp v236, v236, v236 row_ror:4 row_mask:0xf bank_mask:0xf
    v_add_f32_dpp v224, v224, v224 row_ror:2 row_mask:0xf bank_mask:0xf
    v_add_f32_dpp v228, v228, v228 row_ror:2 row_mask:0xf bank_mask:0xf
    v_add_f32_dpp v232, v232, v232 row_ror:2 row_mask:0xf bank_mask:0xf
    v_add_f32_dpp v236, v236, v236 row_ror:2 row_mask:0xf bank_mask:0xf
    v_add_f32_dpp v224, v224, v224 row_ror:1 row_mask:0xf bank_mask:0xf
    v_add_f32_dpp v228, v228, v228 row_ror:1 row_mask:0xf bank_mask:0xf
    v_add_f32_dpp v232, v232, v232 row_ror:1 row_mask:0xf bank_mask:0xf
    v_add_f32_dpp v236, v236, v236 row_ror:1 row_mask:0xf bank_mask:0xf
    s_mov_b32 exec_lo, 0x00010001
    s_mov_b32 exec_hi, 0x00010001
    ds_write_b32 v243, v224 offset:46336
    ds_write_b32 v243, v228 offset:46400
    ds_write_b32 v243, v232 offset:46464
    ds_write_b32 v243, v236 offset:46528
    s_mov_b64 exec, -1
    s_mov_b32 s82, 0x500000
    s_mov_b32 s83, 0x501180
    buffer_store_dword v8, v37, s[16:19], s82 offen offset:0 sc1
    buffer_store_dword v9, v37, s[16:19], s82 offen offset:896 sc1
    buffer_store_dword v10, v37, s[16:19], s82 offen offset:1792 sc1
    buffer_store_dword v11, v37, s[16:19], s82 offen offset:2688 sc1
    buffer_store_dword v12, v37, s[16:19], s82 offen offset:3584 sc1
    buffer_store_dword v13, v37, s[16:19], s83 offen offset:0 sc1
    buffer_store_dword v14, v37, s[16:19], s83 offen offset:896 sc1
    buffer_store_dword v15, v37, s[16:19], s83 offen offset:1792 sc1
    v_lshlrev_b32 v208, 16, v8
    v_and_b32 v209, 0xffff0000, v8
    v_lshlrev_b32 v210, 16, v9
    v_and_b32 v211, 0xffff0000, v9
    v_lshlrev_b32 v212, 16, v10
    v_and_b32 v213, 0xffff0000, v10
    v_lshlrev_b32 v214, 16, v11
    v_and_b32 v215, 0xffff0000, v11
    v_lshlrev_b32 v216, 16, v12
    v_and_b32 v217, 0xffff0000, v12
    v_lshlrev_b32 v218, 16, v13
    v_and_b32 v219, 0xffff0000, v13
    v_lshlrev_b32 v220, 16, v14
    v_and_b32 v221, 0xffff0000, v14
    v_lshlrev_b32 v222, 16, v15
    v_and_b32 v223, 0xffff0000, v15
    s_mov_b32 s62, 0x3b124925
    s_mov_b32 s63, 0x3727c5ac
    s_waitcnt lgkmcnt(0)
    s_barrier
    ds_read_b128 v[224:227], v244 offset:46336
    ds_read_b128 v[228:231], v244 offset:46352
    s_waitcnt lgkmcnt(0)
    v_add_f32 v224, v224, v225
    v_add_f32 v228, v228, v229
    v_add_f32 v226, v226, v227
    v_add_f32 v230, v230, v231
    v_add_f32 v224, v224, v226
    v_add_f32 v228, v228, v230
    v_mul_f32 v224, s62, v224
    v_mul_f32 v228, s62, v228
    v_fma_f32 v228, -v224, v224, v228
    v_max_f32 v228, 0, v228
    v_add_f32 v229, s63, v228
    v_rsq_f32 v229, v229
    s_nop 0
    v_mul_f32 v230, v229, v229
    v_mul_f32 v230, v230, v228
    v_add_f32 v230, s63, v230
    v_rsq_f32 v230, v230
    s_nop 0
    v_mul_f32 v229, v229, v230
    v_readlane_b32 s64, v224, 0
    v_readlane_b32 s65, v229, 0
    v_readlane_b32 s66, v224, 1
    v_readlane_b32 s67, v229, 1
    v_readlane_b32 s68, v224, 2
    v_readlane_b32 s69, v229, 2
    v_readlane_b32 s70, v224, 3
    v_readlane_b32 s71, v229, 3
    v_readlane_b32 s72, v224, 4
    v_readlane_b32 s73, v229, 4
    v_readlane_b32 s74, v224, 5
    v_readlane_b32 s75, v229, 5
    v_readlane_b32 s76, v224, 6
    v_readlane_b32 s77, v229, 6
    v_readlane_b32 s78, v224, 7
    v_readlane_b32 s79, v229, 7
    v_pk_add_f32 v[208:209], v[208:209], s[64:65] op_sel_hi:[1,0] neg_lo:[0,1] neg_hi:[0,1]
    v_pk_add_f32 v[210:211], v[210:211], s[66:67] op_sel_hi:[1,0] neg_lo:[0,1] neg_hi:[0,1]
    v_pk_add_f32 v[212:213], v[212:213], s[68:69] op_sel_hi:[1,0] neg_lo:[0,1] neg_hi:[0,1]
    v_pk_add_f32 v[214:215], v[214:215], s[70:71] op_sel_hi:[1,0] neg_lo:[0,1] neg_hi:[0,1]
    v_pk_add_f32 v[216:217], v[216:217], s[72:73] op_sel_hi:[1,0] neg_lo:[0,1] neg_hi:[0,1]
    v_pk_add_f32 v[218:219], v[218:219], s[74:75] op_sel_hi:[1,0] neg_lo:[0,1] neg_hi:[0,1]
    v_pk_add_f32 v[220:221], v[220:221], s[76:77] op_sel_hi:[1,0] neg_lo:[0,1] neg_hi:[0,1]
    v_pk_add_f32 v[222:223], v[222:223], s[78:79] op_sel_hi:[1,0] neg_lo:[0,1] neg_hi:[0,1]
    v_pk_mul_f32 v[208:209], v[208:209], s[64:65] op_sel:[0,1] op_sel_hi:[1,1]
    v_pk_mul_f32 v[210:211], v[210:211], s[66:67] op_sel:[0,1] op_sel_hi:[1,1]
    v_pk_mul_f32 v[212:213], v[212:213], s[68:69] op_sel:[0,1] op_sel_hi:[1,1]
    v_pk_mul_f32 v[214:215], v[214:215], s[70:71] op_sel:[0,1] op_sel_hi:[1,1]
    v_pk_mul_f32 v[216:217], v[216:217], s[72:73] op_sel:[0,1] op_sel_hi:[1,1]
    v_pk_mul_f32 v[218:219], v[218:219], s[74:75] op_sel:[0,1] op_sel_hi:[1,1]
    v_pk_mul_f32 v[220:221], v[220:221], s[76:77] op_sel:[0,1] op_sel_hi:[1,1]
    v_pk_mul_f32 v[222:223], v[222:223], s[78:79] op_sel:[0,1] op_sel_hi:[1,1]
    v_cvt_pk_bf16_f32 v48, v208, v210
    v_cvt_pk_bf16_f32 v49, v212, v214
    v_cvt_pk_bf16_f32 v50, v216, v218
    v_cvt_pk_bf16_f32 v51, v220, v222
    v_cvt_pk_bf16_f32 v52, v209, v211
    v_cvt_pk_bf16_f32 v53, v213, v215
    v_cvt_pk_bf16_f32 v54, v217, v219
    v_cvt_pk_bf16_f32 v55, v221, v223
    s_mov_b32 vcc_lo, 0x55555555
    s_mov_b32 vcc_hi, 0x55555555
    v_cndmask_b32_dpp v40, v52, v48, vcc quad_perm:[1,0,3,2] row_mask:0xf bank_mask:0xf
    v_cndmask_b32_dpp v41, v53, v49, vcc quad_perm:[1,0,3,2] row_mask:0xf bank_mask:0xf
    v_cndmask_b32_dpp v42, v54, v50, vcc quad_perm:[1,0,3,2] row_mask:0xf bank_mask:0xf
    v_cndmask_b32_dpp v43, v55, v51, vcc quad_perm:[1,0,3,2] row_mask:0xf bank_mask:0xf
    s_mov_b32 vcc_lo, 0xaaaaaaaa
    s_mov_b32 vcc_hi, 0xaaaaaaaa
    v_cndmask_b32_dpp v44, v48, v52, vcc quad_perm:[1,0,3,2] row_mask:0xf bank_mask:0xf
    v_cndmask_b32_dpp v45, v49, v53, vcc quad_perm:[1,0,3,2] row_mask:0xf bank_mask:0xf
    v_cndmask_b32_dpp v46, v50, v54, vcc quad_perm:[1,0,3,2] row_mask:0xf bank_mask:0xf
    v_cndmask_b32_dpp v47, v51, v55, vcc quad_perm:[1,0,3,2] row_mask:0xf bank_mask:0xf
    s_mov_b32 s82, 0x700000
    buffer_store_dwordx4 v[40:43], v38, s[16:19], s82 offen sc1
    buffer_store_dwordx4 v[44:47], v242, s[16:19], s82 offen sc1
    s_waitcnt vmcnt(0)
    s_barrier
    s_cmp_lg_u32 s52, 0
    s_cbranch_scc1 PUB_7
    s_lshl_b32 s62, s2, 7
    v_mov_b32 v2, s3
    s_mov_b64 exec, 1
    buffer_store_dword v2, off, s[16:19], s62 offset:4 sc1
    s_mov_b64 exec, -1
PUB_7:
    s_cmp_lg_u32 s2, 0
    s_cbranch_scc1 EPU_8
    s_cmp_lg_u32 s52, 0
    s_cbranch_scc1 EPU_8
    s_mov_b32 s62, 0x8000
    v_mov_b32 v2, s3
    s_mov_b64 exec, 1
    buffer_store_dword v2, off, s[16:19], s62 sc1
    s_mov_b64 exec, -1
EPU_8:
    s_mov_b32 s28, s40
    s_and_b32 s29, s41, 0xffff
    s_mov_b32 s30, 0xe00
    s_mov_b32 s31, 0x20000
    s_mov_b32 s32, s44
    s_and_b32 s33, s45, 0xffff
    s_mov_b32 s34, 0x1000
    s_mov_b32 s35, 0x20000
    s_lshl_b32 s62, s57, 7
    s_and_b32 s63, s52, 1
    s_lshl_b32 s63, s63, 6
    s_add_u32 s62, s62, s63
    s_or_b32 s62, s62, s95
    v_bfe_u32 v2, v0, 5, 1
    v_lshl_add_u32 v2, v2, 3, s62
    buffer_load_dwordx2 v[16:17], v2, s[28:31], 0 offen offset:0
    buffer_load_dwordx2 v[18:19], v2, s[28:31], 0 offen offset:16
    buffer_load_dwordx2 v[20:21], v2, s[28:31], 0 offen offset:32
    buffer_load_dwordx2 v[22:23], v2, s[28:31], 0 offen offset:48
    v_and_b32 v1, 63, v0
    v_lshlrev_b32 v1, 4, v1
    s_xor_b32 s62, s52, 1
    s_mul_i32 s62, s62, 12288
    v_add_u32 v57, s62, v1
    s_xor_b32 s62, s52, 2
    s_mul_i32 s62, s62, 12288
    v_add_u32 v58, s62, v1
    s_xor_b32 s62, s52, 3
    s_mul_i32 s62, s62, 12288
    v_add_u32 v59, s62, v1
    s_mul_i32 s62, s52, 12288
    v_add_u32 v56, s62, v1
    v_mov_b32 v60, 0xc0135761
    v_mov_b32 v61, 0xc0135761
    v_mov_b32 v62, 1.0
    v_mov_b32 v63, 1.0
    v_and_b32 v2, 63, v0
    s_lshl_b32 s62, s52, 6
    v_add_u32 v2, s62, v2
    v_and_b32 v3, 31, v2
    v_lshlrev_b32 v3, 3, v3
    v_lshrrev_b32 v2, 5, v2
    v_or_b32 v2, v2, v3
    v_lshlrev_b32 v2, 7, v2
    v_or_b32 v42, s95, v2
    s_lshl_b32 s94, s90, 11
    s_add_u32 s94, s94, 0x700000
    ds_read_b64_tr_b16 a[128:129], v28 offset:16384
    ds_read_b64_tr_b16 a[130:131], v28 offset:16896
    ds_read_b64_tr_b16 a[132:133], v29 offset:16384
    ds_read_b64_tr_b16 a[134:135], v29 offset:16896
    s_add_u32 m0, s61, 65536
    s_add_u32 s92, s92, 57344
    s_cmp_eq_u32 s92, 0x1c0000
    s_cselect_b32 s92, 0x0, s92
    buffer_load_dwordx4 v24, s[20:23], s92 offen lds
    buffer_load_dwordx4 v25, s[20:23], s92 offen offset:1024 lds
    ds_read_b64_tr_b16 a[136:137], v28 offset:24576
    ds_read_b64_tr_b16 a[138:139], v28 offset:25088
    ds_read_b64_tr_b16 a[140:141], v29 offset:24576
    ds_read_b64_tr_b16 a[142:143], v29 offset:25088
    s_add_u32 m0, s61, 73728
    s_add_u32 s92, s92, 57344
    s_cmp_eq_u32 s92, 0x1c0000
    s_cselect_b32 s92, 0x0, s92
    buffer_load_dwordx4 v24, s[20:23], s92 offen lds
    buffer_load_dwordx4 v25, s[20:23], s92 offen offset:1024 lds
    ds_read_b64_tr_b16 a[144:145], v28 offset:32768
    ds_read_b64_tr_b16 a[146:147], v28 offset:33280
    ds_read_b64_tr_b16 a[148:149], v29 offset:32768
    ds_read_b64_tr_b16 a[150:151], v29 offset:33280
    s_add_u32 m0, s61, 81920
    s_add_u32 s92, s92, 57344
    s_cmp_eq_u32 s92, 0x1c0000
    s_cselect_b32 s92, 0x0, s92
    buffer_load_dwordx4 v24, s[20:23], s92 offen lds
    buffer_load_dwordx4 v25, s[20:23], s92 offen offset:1024 lds
    ds_read_b64_tr_b16 a[152:153], v28 offset:40960
    ds_read_b64_tr_b16 a[154:155], v28 offset:41472
    ds_read_b64_tr_b16 a[156:157], v29 offset:40960
    ds_read_b64_tr_b16 a[158:159], v29 offset:41472
    s_add_u32 m0, s61, 90112
    s_add_u32 s92, s92, 57344
    s_cmp_eq_u32 s92, 0x1c0000
    s_cselect_b32 s92, 0x0, s92
    buffer_load_dwordx4 v24, s[20:23], s92 offen lds
    buffer_load_dwordx4 v25, s[20:23], s92 offen offset:1024 lds
    ds_read_b64_tr_b16 a[160:161], v28 offset:49152
    ds_read_b64_tr_b16 a[162:163], v28 offset:49664
    ds_read_b64_tr_b16 a[164:165], v29 offset:49152
    ds_read_b64_tr_b16 a[166:167], v29 offset:49664
    s_add_u32 m0, s61, 98304
    s_add_u32 s92, s92, 57344
    s_cmp_eq_u32 s92, 0x1c0000
    s_cselect_b32 s92, 0x0, s92
    buffer_load_dwordx4 v24, s[20:23], s92 offen lds
    buffer_load_dwordx4 v25, s[20:23], s92 offen offset:1024 lds
    ds_read_b64_tr_b16 a[168:169], v30 offset:0
    ds_read_b64_tr_b16 a[170:171], v30 offset:512
    ds_read_b64_tr_b16 a[172:173], v31 offset:0
    ds_read_b64_tr_b16 a[174:175], v31 offset:512
    s_add_u32 m0, s61, 106496
    s_add_u32 s92, s92, 57344
    s_cmp_eq_u32 s92, 0x1c0000
    s_cselect_b32 s92, 0x0, s92
    buffer_load_dwordx4 v24, s[20:23], s92 offen lds
    buffer_load_dwordx4 v25, s[20:23], s92 offen offset:1024 lds
    s_waitcnt vmcnt(10)
    ds_read_b64_tr_b16 a[176:177], v30 offset:8192
    ds_read_b64_tr_b16 a[178:179], v30 offset:8704
    ds_read_b64_tr_b16 a[180:181], v31 offset:8192
    ds_read_b64_tr_b16 a[182:183], v31 offset:8704
    s_add_u32 m0, s61, 0
    s_add_u32 s92, s92, 57344
    s_cmp_eq_u32 s92, 0x1c0000
    s_cselect_b32 s92, 0x0, s92
    buffer_load_dwordx4 v24, s[20:23], s92 offen lds
    buffer_load_dwordx4 v25, s[20:23], s92 offen offset:1024 lds
    s_waitcnt vmcnt(10)
    ds_read_b64_tr_b16 a[184:185], v30 offset:16384
    ds_read_b64_tr_b16 a[186:187], v30 offset:16896
    ds_read_b64_tr_b16 a[188:189], v31 offset:16384
    ds_read_b64_tr_b16 a[190:191], v31 offset:16896
    s_add_u32 m0, s61, 8192
    s_add_u32 s92, s92, 57344
    s_cmp_eq_u32 s92, 0x1c0000
    s_cselect_b32 s92, 0x0, s92
    buffer_load_dwordx4 v24, s[20:23], s92 offen lds
    buffer_load_dwordx4 v25, s[20:23], s92 offen offset:1024 lds
    s_waitcnt vmcnt(10)
    ds_read_b64_tr_b16 a[192:193], v30 offset:24576
    ds_read_b64_tr_b16 a[194:195], v30 offset:25088
    ds_read_b64_tr_b16 a[196:197], v31 offset:24576
    ds_read_b64_tr_b16 a[198:199], v31 offset:25088
    s_waitcnt lgkmcnt(0)
    s_add_u32 m0, s61, 16384
    s_add_u32 s92, s92, 57344
    s_cmp_eq_u32 s92, 0x1c0000
    s_cselect_b32 s92, 0x0, s92
    buffer_load_dwordx4 v24, s[20:23], s92 offen lds
    buffer_load_dwordx4 v25, s[20:23], s92 offen offset:1024 lds
    s_waitcnt vmcnt(10)
    ds_read_b64_tr_b16 a[200:201], v30 offset:32768
    ds_read_b64_tr_b16 a[202:203], v30 offset:33280
    ds_read_b64_tr_b16 a[204:205], v31 offset:32768
    ds_read_b64_tr_b16 a[206:207], v31 offset:33280
    s_add_u32 m0, s61, 24576
    s_add_u32 s92, s92, 57344
    s_cmp_eq_u32 s92, 0x1c0000
    s_cselect_b32 s92, 0x0, s92
    buffer_load_dwordx4 v24, s[20:23], s92 offen lds
    buffer_load_dwordx4 v25, s[20:23], s92 offen offset:1024 lds
    buffer_load_dword v43, v42, s[16:19], 0 offen offset:4 sc1
    s_waitcnt vmcnt(11)
    ds_read_b64_tr_b16 a[208:209], v30 offset:40960
    ds_read_b64_tr_b16 a[210:211], v30 offset:41472
    ds_read_b64_tr_b16 a[212:213], v31 offset:40960
    ds_read_b64_tr_b16 a[214:215], v31 offset:41472
    s_add_u32 m0, s61, 32768
    s_add_u32 s93, s93, 65536
    buffer_load_dwordx4 v26, s[24:27], s93 offen lds
    buffer_load_dwordx4 v27, s[24:27], s93 offen offset:1024 lds
    s_add_u32 m0, s61, 40960
    s_add_u32 s93, s93, 65536
    buffer_load_dwordx4 v26, s[24:27], s93 offen lds
    buffer_load_dwordx4 v27, s[24:27], s93 offen offset:1024 lds
    s_add_u32 m0, s61, 49152
    s_add_u32 s93, s93, 65536
    buffer_load_dwordx4 v26, s[24:27], s93 offen lds
    buffer_load_dwordx4 v27, s[24:27], s93 offen offset:1024 lds
    s_add_u32 m0, s61, 57344
    s_add_u32 s93, s93, 65536
    buffer_load_dwordx4 v26, s[24:27], s93 offen lds
    buffer_load_dwordx4 v27, s[24:27], s93 offen offset:1024 lds
    s_add_u32 m0, s61, 65536
    s_add_u32 s93, s93, 65536
    buffer_load_dwordx4 v26, s[24:27], s93 offen lds
    buffer_load_dwordx4 v27, s[24:27], s93 offen offset:1024 lds
    s_add_u32 m0, s61, 73728
    s_add_u32 s93, s93, 65536
    buffer_load_dwordx4 v26, s[24:27], s93 offen lds
    buffer_load_dwordx4 v27, s[24:27], s93 offen offset:1024 lds
    s_mov_b32 s80, 0
    s_waitcnt vmcnt(12)
    s_branch G4_9_chk
G4_9:
    buffer_load_dword v43, v42, s[16:19], 0 offen offset:4 sc1
    s_waitcnt vmcnt(0)
G4_9_chk:
    v_cmp_le_i32 vcc, 0, v42
    v_mov_b32 v44, s3
    s_nop 0
    v_cndmask_b32 v43, v44, v43, vcc
    v_cmp_ne_u32 vcc, s3, v43
    s_cbranch_vccz G4_9_ok
    s_add_u32 s80, s80, 1
    s_cmp_gt_u32 s80, 40000
    s_cbranch_scc1 G4_9_ok
    s_sleep 1
    s_branch G4_9
G4_9_ok:
    buffer_load_dwordx4 v[128:131], v32, s[16:19], s94 offen sc1
    buffer_load_dwordx4 v[132:135], v33, s[16:19], s94 offen sc1
    s_add_u32 s94, s94, 2048
    s_cmp_eq_u32 s94, 0x710000
    s_cselect_b32 s94, 0x700000, s94
    buffer_load_dwordx4 v[136:139], v32, s[16:19], s94 offen sc1
    buffer_load_dwordx4 v[140:143], v33, s[16:19], s94 offen sc1
    s_add_u32 s94, s94, 2048
    s_cmp_eq_u32 s94, 0x710000
    s_cselect_b32 s94, 0x700000, s94
    buffer_load_dwordx4 v[144:147], v32, s[16:19], s94 offen sc1
    buffer_load_dwordx4 v[148:151], v33, s[16:19], s94 offen sc1
    s_add_u32 s94, s94, 2048
    s_cmp_eq_u32 s94, 0x710000
    s_cselect_b32 s94, 0x700000, s94
    buffer_load_dwordx4 v[152:155], v32, s[16:19], s94 offen sc1
    buffer_load_dwordx4 v[156:159], v33, s[16:19], s94 offen sc1
    s_add_u32 s94, s94, 2048
    s_cmp_eq_u32 s94, 0x710000
    s_cselect_b32 s94, 0x700000, s94
    buffer_load_dwordx4 v[160:163], v32, s[16:19], s94 offen sc1
    buffer_load_dwordx4 v[164:167], v33, s[16:19], s94 offen sc1
    s_add_u32 s94, s94, 2048
    s_cmp_eq_u32 s94, 0x710000
    s_cselect_b32 s94, 0x700000, s94
    v_lshlrev_b32 v64, 16, v16
    v_and_b32 v65, 0xffff0000, v16
    v_lshlrev_b32 v66, 16, v17
    v_and_b32 v67, 0xffff0000, v17
    v_lshlrev_b32 v68, 16, v18
    v_and_b32 v69, 0xffff0000, v18
    v_lshlrev_b32 v70, 16, v19
    v_and_b32 v71, 0xffff0000, v19
    v_lshlrev_b32 v72, 16, v20
    v_and_b32 v73, 0xffff0000, v20
    v_lshlrev_b32 v74, 16, v21
    v_and_b32 v75, 0xffff0000, v21
    v_lshlrev_b32 v76, 16, v22
    v_and_b32 v77, 0xffff0000, v22
    v_lshlrev_b32 v78, 16, v23
    v_and_b32 v79, 0xffff0000, v23
    s_waitcnt vmcnt(8)
    s_nop 0
    v_mfma_f32_32x32x16_bf16 v[64:79], a[0:3], v[128:131], v[64:79]
    buffer_load_dwordx4 v[168:171], v32, s[16:19], s94 offen sc1
    buffer_load_dwordx4 v[172:175], v33, s[16:19], s94 offen sc1
    s_add_u32 s94, s94, 2048
    s_cmp_eq_u32 s94, 0x710000
    s_cselect_b32 s94, 0x700000, s94
    v_mfma_f32_32x32x16_bf16 v[80:95], a[4:7], v[128:131], 0
    v_mfma_f32_32x32x16_bf16 v[96:111], a[0:3], v[132:135], 0
    v_mfma_f32_32x32x16_bf16 v[112:127], a[4:7], v[132:135], 0
    ds_read_b64_tr_b16 a[0:1], v28 offset:32768
    ds_read_b64_tr_b16 a[2:3], v28 offset:33280
    ds_read_b64_tr_b16 a[4:5], v29 offset:32768
    ds_read_b64_tr_b16 a[6:7], v29 offset:33280
    s_waitcnt vmcnt(8)
    v_mfma_f32_32x32x16_bf16 v[64:79], a[8:11], v[136:139], v[64:79]
    buffer_load_dwordx4 v[176:179], v32, s[16:19], s94 offen sc1
    buffer_load_dwordx4 v[180:183], v33, s[16:19], s94 offen sc1
    s_add_u32 s94, s94, 2048
    s_cmp_eq_u32 s94, 0x710000
    s_cselect_b32 s94, 0x700000, s94
    v_mfma_f32_32x32x16_bf16 v[80:95], a[12:15], v[136:139], v[80:95]
    v_mfma_f32_32x32x16_bf16 v[96:111], a[8:11], v[140:143], v[96:111]
    v_mfma_f32_32x32x16_bf16 v[112:127], a[12:15], v[140:143], v[112:127]
    ds_read_b64_tr_b16 a[8:9], v28 offset:40960
    ds_read_b64_tr_b16 a[10:11], v28 offset:41472
    ds_read_b64_tr_b16 a[12:13], v29 offset:40960
    ds_read_b64_tr_b16 a[14:15], v29 offset:41472
    s_waitcnt vmcnt(8)
    v_mfma_f32_32x32x16_bf16 v[64:79], a[16:19], v[144:147], v[64:79]
    buffer_load_dwordx4 v[184:187], v32, s[16:19], s94 offen sc1
    buffer_load_dwordx4 v[188:191], v33, s[16:19], s94 offen sc1
    s_add_u32 s94, s94, 2048
    s_cmp_eq_u32 s94, 0x710000
    s_cselect_b32 s94, 0x700000, s94
    v_mfma_f32_32x32x16_bf16 v[80:95], a[20:23], v[144:147], v[80:95]
    v_mfma_f32_32x32x16_bf16 v[96:111], a[16:19], v[148:151], v[96:111]
    v_mfma_f32_32x32x16_bf16 v[112:127], a[20:23], v[148:151], v[112:127]
    ds_read_b64_tr_b16 a[16:17], v28 offset:49152
    ds_read_b64_tr_b16 a[18:19], v28 offset:49664
    ds_read_b64_tr_b16 a[20:21], v29 offset:49152
    ds_read_b64_tr_b16 a[22:23], v29 offset:49664
    s_waitcnt vmcnt(8)
    v_mfma_f32_32x32x16_bf16 v[64:79], a[24:27], v[152:155], v[64:79]
    buffer_load_dwordx4 v[128:131], v32, s[16:19], s94 offen sc1
    buffer_load_dwordx4 v[132:135], v33, s[16:19], s94 offen sc1
    s_add_u32 s94, s94, 2048
    s_cmp_eq_u32 s94, 0x710000
    s_cselect_b32 s94, 0x700000, s94
    v_mfma_f32_32x32x16_bf16 v[80:95], a[28:31], v[152:155], v[80:95]
    v_mfma_f32_32x32x16_bf16 v[96:111], a[24:27], v[156:159], v[96:111]
    v_mfma_f32_32x32x16_bf16 v[112:127], a[28:31], v[156:159], v[112:127]
    ds_read_b64_tr_b16 a[24:25], v30 offset:0
    ds_read_b64_tr_b16 a[26:27], v30 offset:512
    ds_read_b64_tr_b16 a[28:29], v31 offset:0
    ds_read_b64_tr_b16 a[30:31], v31 offset:512
    s_waitcnt vmcnt(8)
    v_mfma_f32_32x32x16_bf16 v[64:79], a[32:35], v[160:163], v[64:79]
    buffer_load_dwordx4 v[136:139], v32, s[16:19], s94 offen sc1
    buffer_load_dwordx4 v[140:143], v33, s[16:19], s94 offen sc1
    s_add_u32 s94, s94, 2048
    s_cmp_eq_u32 s94, 0x710000
    s_cselect_b32 s94, 0x700000, s94
    v_mfma_f32_32x32x16_bf16 v[80:95], a[36:39], v[160:163], v[80:95]
    v_mfma_f32_32x32x16_bf16 v[96:111], a[32:35], v[164:167], v[96:111]
    v_mfma_f32_32x32x16_bf16 v[112:127], a[36:39], v[164:167], v[112:127]
    ds_read_b64_tr_b16 a[32:33], v30 offset:8192
    ds_read_b64_tr_b16 a[34:35], v30 offset:8704
    ds_read_b64_tr_b16 a[36:37], v31 offset:8192
    ds_read_b64_tr_b16 a[38:39], v31 offset:8704
    s_waitcnt vmcnt(8)
    v_mfma_f32_32x32x16_bf16 v[64:79], a[40:43], v[168:171], v[64:79]
    buffer_load_dwordx4 v[144:147], v32, s[16:19], s94 offen sc1
    buffer_load_dwordx4 v[148:151], v33, s[16:19], s94 offen sc1
    s_add_u32 s94, s94, 2048
    s_cmp_eq_u32 s94, 0x710000
    s_cselect_b32 s94, 0x700000, s94
    v_mfma_f32_32x32x16_bf16 v[80:95], a[44:47], v[168:171], v[80:95]
    v_mfma_f32_32x32x16_bf16 v[96:111], a[40:43], v[172:175], v[96:111]
    v_mfma_f32_32x32x16_bf16 v[112:127], a[44:47], v[172:175], v[112:127]
    ds_read_b64_tr_b16 a[40:41], v30 offset:16384
    ds_read_b64_tr_b16 a[42:43], v30 offset:16896
    ds_read_b64_tr_b16 a[44:45], v31 offset:16384
    ds_read_b64_tr_b16 a[46:47], v31 offset:16896
    s_waitcnt vmcnt(8)
    v_mfma_f32_32x32x16_bf16 v[64:79], a[48:51], v[176:179], v[64:79]
    buffer_load_dwordx4 v[152:155], v32, s[16:19], s94 offen sc1
    buffer_load_dwordx4 v[156:159], v33, s[16:19], s94 offen sc1
    s_add_u32 s94, s94, 2048
    s_cmp_eq_u32 s94, 0x710000
    s_cselect_b32 s94, 0x700000, s94
    v_mfma_f32_32x32x16_bf16 v[80:95], a[52:55], v[176:179], v[80:95]
    v_mfma_f32_32x32x16_bf16 v[96:111], a[48:51], v[180:183], v[96:111]
    v_mfma_f32_32x32x16_bf16 v[112:127], a[52:55], v[180:183], v[112:127]
    s_waitcnt vmcnt(8)
    v_mfma_f32_32x32x16_bf16 v[64:79], a[56:59], v[184:187], v[64:79]
    buffer_load_dwordx4 v[160:163], v32, s[16:19], s94 offen sc1
    buffer_load_dwordx4 v[164:167], v33, s[16:19], s94 offen sc1
    s_add_u32 s94, s94, 2048
    s_cmp_eq_u32 s94, 0x710000
    s_cselect_b32 s94, 0x700000, s94
    v_mfma_f32_32x32x16_bf16 v[80:95], a[60:63], v[184:187], v[80:95]
    v_mfma_f32_32x32x16_bf16 v[96:111], a[56:59], v[188:191], v[96:111]
    v_mfma_f32_32x32x16_bf16 v[112:127], a[60:63], v[188:191], v[112:127]
    s_waitcnt vmcnt(8)
    v_mfma_f32_32x32x16_bf16 v[64:79], a[64:67], v[128:131], v[64:79]
    buffer_load_dwordx4 v[168:171], v32, s[16:19], s94 offen sc1
    buffer_load_dwordx4 v[172:175], v33, s[16:19], s94 offen sc1
    s_add_u32 s94, s94, 2048
    s_cmp_eq_u32 s94, 0x710000
    s_cselect_b32 s94, 0x700000, s94
    v_mfma_f32_32x32x16_bf16 v[80:95], a[68:71], v[128:131], v[80:95]
    v_mfma_f32_32x32x16_bf16 v[96:111], a[64:67], v[132:135], v[96:111]
    v_mfma_f32_32x32x16_bf16 v[112:127], a[68:71], v[132:135], v[112:127]
    s_waitcnt vmcnt(8)
    v_mfma_f32_32x32x16_bf16 v[64:79], a[72:75], v[136:139], v[64:79]
    buffer_load_dwordx4 v[176:179], v32, s[16:19], s94 offen sc1
    buffer_load_dwordx4 v[180:183], v33, s[16:19], s94 offen sc1
    s_add_u32 s94, s94, 2048
    s_cmp_eq_u32 s94, 0x710000
    s_cselect_b32 s94, 0x700000, s94
    v_mfma_f32_32x32x16_bf16 v[80:95], a[76:79], v[136:139], v[80:95]
    v_mfma_f32_32x32x16_bf16 v[96:111], a[72:75], v[140:143], v[96:111]
    v_mfma_f32_32x32x16_bf16 v[112:127], a[76:79], v[140:143], v[112:127]
    s_waitcnt vmcnt(8)
    v_mfma_f32_32x32x16_bf16 v[64:79], a[80:83], v[144:147], v[64:79]
    buffer_load_dwordx4 v[184:187], v32, s[16:19], s94 offen sc1
    buffer_load_dwordx4 v[188:191], v33, s[16:19], s94 offen sc1
    s_add_u32 s94, s94, 2048
    s_cmp_eq_u32 s94, 0x710000
    s_cselect_b32 s94, 0x700000, s94
    v_mfma_f32_32x32x16_bf16 v[80:95], a[84:87], v[144:147], v[80:95]
    v_mfma_f32_32x32x16_bf16 v[96:111], a[80:83], v[148:151], v[96:111]
    v_mfma_f32_32x32x16_bf16 v[112:127], a[84:87], v[148:151], v[112:127]
    s_waitcnt vmcnt(8)
    v_mfma_f32_32x32x16_bf16 v[64:79], a[88:91], v[152:155], v[64:79]
    buffer_load_dwordx4 v[128:131], v32, s[16:19], s94 offen sc1
    buffer_load_dwordx4 v[132:135], v33, s[16:19], s94 offen sc1
    s_add_u32 s94, s94, 2048
    s_cmp_eq_u32 s94, 0x710000
    s_cselect_b32 s94, 0x700000, s94
    v_mfma_f32_32x32x16_bf16 v[80:95], a[92:95], v[152:155], v[80:95]
    v_mfma_f32_32x32x16_bf16 v[96:111], a[88:91], v[156:159], v[96:111]
    v_mfma_f32_32x32x16_bf16 v[112:127], a[92:95], v[156:159], v[112:127]
    s_waitcnt vmcnt(8)
    v_mfma_f32_32x32x16_bf16 v[64:79], a[96:99], v[160:163], v[64:79]
    buffer_load_dwordx4 v[136:139], v32, s[16:19], s94 offen sc1
    buffer_load_dwordx4 v[140:143], v33, s[16:19], s94 offen sc1
    s_add_u32 s94, s94, 2048
    s_cmp_eq_u32 s94, 0x710000
    s_cselect_b32 s94, 0x700000, s94
    v_mfma_f32_32x32x16_bf16 v[80:95], a[100:103], v[160:163], v[80:95]
    v_mfma_f32_32x32x16_bf16 v[96:111], a[96:99], v[164:167], v[96:111]
    v_mfma_f32_32x32x16_bf16 v[112:127], a[100:103], v[164:167], v[112:127]
    s_waitcnt vmcnt(8)
    v_mfma_f32_32x32x16_bf16 v[64:79], a[104:107], v[168:171], v[64:79]
    buffer_load_dwordx4 v[144:147], v32, s[16:19], s94 offen sc1
    buffer_load_dwordx4 v[148:151], v33, s[16:19], s94 offen sc1
    s_add_u32 s94, s94, 2048
    s_cmp_eq_u32 s94, 0x710000
    s_cselect_b32 s94, 0x700000, s94
    v_mfma_f32_32x32x16_bf16 v[80:95], a[108:111], v[168:171], v[80:95]
    v_mfma_f32_32x32x16_bf16 v[96:111], a[104:107], v[172:175], v[96:111]
    v_mfma_f32_32x32x16_bf16 v[112:127], a[108:111], v[172:175], v[112:127]
    s_waitcnt vmcnt(8)
    v_mfma_f32_32x32x16_bf16 v[64:79], a[112:115], v[176:179], v[64:79]
    buffer_load_dwordx4 v[152:155], v32, s[16:19], s94 offen sc1
    buffer_load_dwordx4 v[156:159], v33, s[16:19], s94 offen sc1
    s_add_u32 s94, s94, 2048
    s_cmp_eq_u32 s94, 0x710000
    s_cselect_b32 s94, 0x700000, s94
    v_mfma_f32_32x32x16_bf16 v[80:95], a[116:119], v[176:179], v[80:95]
    v_mfma_f32_32x32x16_bf16 v[96:111], a[112:115], v[180:183], v[96:111]
    v_mfma_f32_32x32x16_bf16 v[112:127], a[116:119], v[180:183], v[112:127]
    s_waitcnt vmcnt(8)
    v_mfma_f32_32x32x16_bf16 v[64:79], a[120:123], v[184:187], v[64:79]
    buffer_load_dwordx4 v[160:163], v32, s[16:19], s94 offen sc1
    buffer_load_dwordx4 v[164:167], v33, s[16:19], s94 offen sc1
    s_add_u32 s94, s94, 2048
    s_cmp_eq_u32 s94, 0x710000
    s_cselect_b32 s94, 0x700000, s94
    v_mfma_f32_32x32x16_bf16 v[80:95], a[124:127], v[184:187], v[80:95]
    v_mfma_f32_32x32x16_bf16 v[96:111], a[120:123], v[188:191], v[96:111]
    v_mfma_f32_32x32x16_bf16 v[112:127], a[124:127], v[188:191], v[112:127]
    s_waitcnt vmcnt(8)
    v_mfma_f32_32x32x16_bf16 v[64:79], a[128:131], v[128:131], v[64:79]
    buffer_load_dwordx4 v[168:171], v32, s[16:19], s94 offen sc1
    buffer_load_dwordx4 v[172:175], v33, s[16:19], s94 offen sc1
    s_add_u32 s94, s94, 2048
    s_cmp_eq_u32 s94, 0x710000
    s_cselect_b32 s94, 0x700000, s94
    v_mfma_f32_32x32x16_bf16 v[80:95], a[132:135], v[128:131], v[80:95]
    v_mfma_f32_32x32x16_bf16 v[96:111], a[128:131], v[132:135], v[96:111]
    v_mfma_f32_32x32x16_bf16 v[112:127], a[132:135], v[132:135], v[112:127]
    s_waitcnt vmcnt(8)
    v_mfma_f32_32x32x16_bf16 v[64:79], a[136:139], v[136:139], v[64:79]
    buffer_load_dwordx4 v[176:179], v32, s[16:19], s94 offen sc1
    buffer_load_dwordx4 v[180:183], v33, s[16:19], s94 offen sc1
    s_add_u32 s94, s94, 2048
    s_cmp_eq_u32 s94, 0x710000
    s_cselect_b32 s94, 0x700000, s94
    v_mfma_f32_32x32x16_bf16 v[80:95], a[140:143], v[136:139], v[80:95]
    v_mfma_f32_32x32x16_bf16 v[96:111], a[136:139], v[140:143], v[96:111]
    v_mfma_f32_32x32x16_bf16 v[112:127], a[140:143], v[140:143], v[112:127]
    s_waitcnt vmcnt(8)
    v_mfma_f32_32x32x16_bf16 v[64:79], a[144:147], v[144:147], v[64:79]
    buffer_load_dwordx4 v[184:187], v32, s[16:19], s94 offen sc1
    buffer_load_dwordx4 v[188:191], v33, s[16:19], s94 offen sc1
    s_add_u32 s94, s94, 2048
    s_cmp_eq_u32 s94, 0x710000
    s_cselect_b32 s94, 0x700000, s94
    v_mfma_f32_32x32x16_bf16 v[80:95], a[148:151], v[144:147], v[80:95]
    v_mfma_f32_32x32x16_bf16 v[96:111], a[144:147], v[148:151], v[96:111]
    v_mfma_f32_32x32x16_bf16 v[112:127], a[148:151], v[148:151], v[112:127]
    s_waitcnt vmcnt(8)
    v_mfma_f32_32x32x16_bf16 v[64:79], a[152:155], v[152:155], v[64:79]
    buffer_load_dwordx4 v[128:131], v32, s[16:19], s94 offen sc1
    buffer_load_dwordx4 v[132:135], v33, s[16:19], s94 offen sc1
    s_add_u32 s94, s94, 2048
    s_cmp_eq_u32 s94, 0x710000
    s_cselect_b32 s94, 0x700000, s94
    v_mfma_f32_32x32x16_bf16 v[80:95], a[156:159], v[152:155], v[80:95]
    v_mfma_f32_32x32x16_bf16 v[96:111], a[152:155], v[156:159], v[96:111]
    v_mfma_f32_32x32x16_bf16 v[112:127], a[156:159], v[156:159], v[112:127]
    s_waitcnt vmcnt(8)
    v_mfma_f32_32x32x16_bf16 v[64:79], a[160:163], v[160:163], v[64:79]
    buffer_load_dwordx4 v[136:139], v32, s[16:19], s94 offen sc1
    buffer_load_dwordx4 v[140:143], v33, s[16:19], s94 offen sc1
    s_add_u32 s94, s94, 2048
    s_cmp_eq_u32 s94, 0x710000
    s_cselect_b32 s94, 0x700000, s94
    v_mfma_f32_32x32x16_bf16 v[80:95], a[164:167], v[160:163], v[80:95]
    v_mfma_f32_32x32x16_bf16 v[96:111], a[160:163], v[164:167], v[96:111]
    v_mfma_f32_32x32x16_bf16 v[112:127], a[164:167], v[164:167], v[112:127]
    s_waitcnt vmcnt(8)
    v_mfma_f32_32x32x16_bf16 v[64:79], a[168:171], v[168:171], v[64:79]
    buffer_load_dwordx4 v[144:147], v32, s[16:19], s94 offen sc1
    buffer_load_dwordx4 v[148:151], v33, s[16:19], s94 offen sc1
    s_add_u32 s94, s94, 2048
    s_cmp_eq_u32 s94, 0x710000
    s_cselect_b32 s94, 0x700000, s94
    v_mfma_f32_32x32x16_bf16 v[80:95], a[172:175], v[168:171], v[80:95]
    v_mfma_f32_32x32x16_bf16 v[96:111], a[168:171], v[172:175], v[96:111]
    v_mfma_f32_32x32x16_bf16 v[112:127], a[172:175], v[172:175], v[112:127]
    s_waitcnt vmcnt(8)
    v_mfma_f32_32x32x16_bf16 v[64:79], a[176:179], v[176:179], v[64:79]
    buffer_load_dwordx4 v[152:155], v32, s[16:19], s94 offen sc1
    buffer_load_dwordx4 v[156:159], v33, s[16:19], s94 offen sc1
    s_add_u32 s94, s94, 2048
    s_cmp_eq_u32 s94, 0x710000
    s_cselect_b32 s94, 0x700000, s94
    v_mfma_f32_32x32x16_bf16 v[80:95], a[180:183], v[176:179], v[80:95]
    v_mfma_f32_32x32x16_bf16 v[96:111], a[176:179], v[180:183], v[96:111]
    v_mfma_f32_32x32x16_bf16 v[112:127], a[180:183], v[180:183], v[112:127]
    s_waitcnt vmcnt(8)
    v_mfma_f32_32x32x16_bf16 v[64:79], a[184:187], v[184:187], v[64:79]
    buffer_load_dwordx4 v[160:163], v32, s[16:19], s94 offen sc1
    buffer_load_dwordx4 v[164:167], v33, s[16:19], s94 offen sc1
    s_add_u32 s94, s94, 2048
    s_cmp_eq_u32 s94, 0x710000
    s_cselect_b32 s94, 0x700000, s94
    v_mfma_f32_32x32x16_bf16 v[80:95], a[188:191], v[184:187], v[80:95]
    v_mfma_f32_32x32x16_bf16 v[96:111], a[184:187], v[188:191], v[96:111]
    v_mfma_f32_32x32x16_bf16 v[112:127], a[188:191], v[188:191], v[112:127]
    s_waitcnt vmcnt(8)
    v_mfma_f32_32x32x16_bf16 v[64:79], a[192:195], v[128:131], v[64:79]
    buffer_load_dwordx4 v[168:171], v32, s[16:19], s94 offen sc1
    buffer_load_dwordx4 v[172:175], v33, s[16:19], s94 offen sc1
    s_add_u32 s94, s94, 2048
    s_cmp_eq_u32 s94, 0x710000
    s_cselect_b32 s94, 0x700000, s94
    v_mfma_f32_32x32x16_bf16 v[80:95], a[196:199], v[128:131], v[80:95]
    v_mfma_f32_32x32x16_bf16 v[96:111], a[192:195], v[132:135], v[96:111]
    v_mfma_f32_32x32x16_bf16 v[112:127], a[196:199], v[132:135], v[112:127]
    s_waitcnt vmcnt(8)
    s_waitcnt lgkmcnt(14)
    v_mfma_f32_32x32x16_bf16 v[64:79], a[200:203], v[136:139], v[64:79]
    buffer_load_dwordx4 v[176:179], v32, s[16:19], s94 offen sc1
    buffer_load_dwordx4 v[180:183], v33, s[16:19], s94 offen sc1
    s_add_u32 s94, s94, 2048
    s_cmp_eq_u32 s94, 0x710000
    s_cselect_b32 s94, 0x700000, s94
    ds_read_b64_tr_b16 a[216:217], v30 offset:49152
    ds_read_b64_tr_b16 a[218:219], v30 offset:49664
    ds_read_b64_tr_b16 a[220:221], v31 offset:49152
    ds_read_b64_tr_b16 a[222:223], v31 offset:49664
    v_mfma_f32_32x32x16_bf16 v[80:95], a[204:207], v[136:139], v[80:95]
    v_mfma_f32_32x32x16_bf16 v[96:111], a[200:203], v[140:143], v[96:111]
    v_mfma_f32_32x32x16_bf16 v[112:127], a[204:207], v[140:143], v[112:127]
    s_waitcnt vmcnt(8)
    v_mfma_f32_32x32x16_bf16 v[64:79], a[208:211], v[144:147], v[64:79]
    buffer_load_dwordx4 v[184:187], v32, s[16:19], s94 offen sc1
    buffer_load_dwordx4 v[188:191], v33, s[16:19], s94 offen sc1
    s_add_u32 s94, s94, 2048
    s_cmp_eq_u32 s94, 0x710000
    s_cselect_b32 s94, 0x700000, s94
    ds_read_b64_tr_b16 a[224:225], v28 offset:0
    ds_read_b64_tr_b16 a[226:227], v28 offset:512
    ds_read_b64_tr_b16 a[228:229], v29 offset:0
    ds_read_b64_tr_b16 a[230:231], v29 offset:512
    v_mfma_f32_32x32x16_bf16 v[80:95], a[212:215], v[144:147], v[80:95]
    v_mfma_f32_32x32x16_bf16 v[96:111], a[208:211], v[148:151], v[96:111]
    v_mfma_f32_32x32x16_bf16 v[112:127], a[212:215], v[148:151], v[112:127]
    s_waitcnt vmcnt(8)
    s_waitcnt lgkmcnt(4)
    v_mfma_f32_32x32x16_bf16 v[64:79], a[216:219], v[152:155], v[64:79]
    ds_read_b64_tr_b16 a[232:233], v28 offset:8192
    ds_read_b64_tr_b16 a[234:235], v28 offset:8704
    ds_read_b64_tr_b16 a[236:237], v29 offset:8192
    ds_read_b64_tr_b16 a[238:239], v29 offset:8704
    s_waitcnt lgkmcnt(0)
    v_mfma_f32_32x32x16_bf16 v[80:95], a[220:223], v[152:155], v[80:95]
    v_mfma_f32_32x32x16_bf16 v[96:111], a[216:219], v[156:159], v[96:111]
    v_mfma_f32_32x32x16_bf16 v[112:127], a[220:223], v[156:159], v[112:127]
    s_waitcnt vmcnt(6)
    v_mfma_f32_32x32x16_bf16 v[64:79], a[224:227], v[160:163], v[64:79]
    ds_read_b64_tr_b16 a[240:241], v28 offset:16384
    ds_read_b64_tr_b16 a[242:243], v28 offset:16896
    ds_read_b64_tr_b16 a[244:245], v29 offset:16384
    ds_read_b64_tr_b16 a[246:247], v29 offset:16896
    s_waitcnt lgkmcnt(0)
    v_mfma_f32_32x32x16_bf16 v[80:95], a[228:231], v[160:163], v[80:95]
    v_mfma_f32_32x32x16_bf16 v[96:111], a[224:227], v[164:167], v[96:111]
    v_mfma_f32_32x32x16_bf16 v[112:127], a[228:231], v[164:167], v[112:127]
    s_waitcnt vmcnt(4)
    v_mfma_f32_32x32x16_bf16 v[64:79], a[232:235], v[168:171], v[64:79]
    ds_read_b64_tr_b16 a[248:249], v28 offset:24576
    ds_read_b64_tr_b16 a[250:251], v28 offset:25088
    ds_read_b64_tr_b16 a[252:253], v29 offset:24576
    ds_read_b64_tr_b16 a[254:255], v29 offset:25088
    s_waitcnt lgkmcnt(0)
    v_mfma_f32_32x32x16_bf16 v[80:95], a[236:239], v[168:171], v[80:95]
    v_mfma_f32_32x32x16_bf16 v[96:111], a[232:235], v[172:175], v[96:111]
    v_mfma_f32_32x32x16_bf16 v[112:127], a[236:239], v[172:175], v[112:127]
    s_waitcnt vmcnt(2)
    v_mfma_f32_32x32x16_bf16 v[64:79], a[240:243], v[176:179], v[64:79]
    v_mfma_f32_32x32x16_bf16 v[80:95], a[244:247], v[176:179], v[80:95]
    v_mfma_f32_32x32x16_bf16 v[96:111], a[240:243], v[180:183], v[96:111]
    v_mfma_f32_32x32x16_bf16 v[112:127], a[244:247], v[180:183], v[112:127]
    s_waitcnt vmcnt(0)
    v_mfma_f32_32x32x16_bf16 v[64:79], a[248:251], v[184:187], v[64:79]
    v_mfma_f32_32x32x16_bf16 v[80:95], a[252:255], v[184:187], v[80:95]
    v_mfma_f32_32x32x16_bf16 v[96:111], a[248:251], v[188:191], v[96:111]
    v_mfma_f32_32x32x16_bf16 v[112:127], a[252:255], v[188:191], v[112:127]
    s_nop 9
    ds_write_b128 v57, v[80:83] offset:0
    ds_write_b128 v57, v[84:87] offset:1024
    ds_write_b128 v57, v[88:91] offset:2048
    ds_write_b128 v57, v[92:95] offset:3072
    ds_write_b128 v58, v[96:99] offset:4096
    ds_write_b128 v58, v[100:103] offset:5120
    ds_write_b128 v58, v[104:107] offset:6144
    ds_write_b128 v58, v[108:111] offset:7168
    ds_write_b128 v59, v[112:115] offset:8192
    ds_write_b128 v59, v[116:119] offset:9216
    ds_write_b128 v59, v[120:123] offset:10240
    ds_write_b128 v59, v[124:127] offset:11264
    s_waitcnt lgkmcnt(0)
    s_barrier
    ds_read_b128 v[80:83], v56 offset:0
    ds_read_b128 v[84:87], v56 offset:1024
    ds_read_b128 v[88:91], v56 offset:2048
    ds_read_b128 v[92:95], v56 offset:3072
    ds_read_b128 v[96:99], v56 offset:4096
    ds_read_b128 v[100:103], v56 offset:5120
    ds_read_b128 v[104:107], v56 offset:6144
    ds_read_b128 v[108:111], v56 offset:7168
    ds_read_b128 v[112:115], v56 offset:8192
    ds_read_b128 v[116:119], v56 offset:9216
    ds_read_b128 v[120:123], v56 offset:10240
    ds_read_b128 v[124:127], v56 offset:11264
    s_add_u32 m0, s61, 81920
    s_add_u32 s93, s93, 65536
    buffer_load_dwordx4 v26, s[24:27], s93 offen lds
    buffer_load_dwordx4 v27, s[24:27], s93 offen offset:1024 lds
    s_add_u32 m0, s61, 90112
    s_add_u32 s93, s93, 65536
    buffer_load_dwordx4 v26, s[24:27], s93 offen lds
    buffer_load_dwordx4 v27, s[24:27], s93 offen offset:1024 lds
    s_add_u32 m0, s61, 98304
    s_add_u32 s93, s93, 65536
    buffer_load_dwordx4 v26, s[24:27], s93 offen lds
    buffer_load_dwordx4 v27, s[24:27], s93 offen offset:1024 lds
    s_add_u32 m0, s61, 32768
    s_add_u32 s93, s93, 65536
    buffer_load_dwordx4 v26, s[24:27], s93 offen lds
    buffer_load_dwordx4 v27, s[24:27], s93 offen offset:1024 lds
    s_add_u32 m0, s61, 40960
    s_add_u32 s93, s93, 65536
    buffer_load_dwordx4 v26, s[24:27], s93 offen lds
    buffer_load_dwordx4 v27, s[24:27], s93 offen offset:1024 lds
    s_add_u32 m0, s61, 49152
    s_add_u32 s93, s93, 65536
    buffer_load_dwordx4 v26, s[24:27], s93 offen lds
    buffer_load_dwordx4 v27, s[24:27], s93 offen offset:1024 lds
    s_add_u32 m0, s61, 57344
    s_add_u32 s93, s93, 65536
    buffer_load_dwordx4 v26, s[24:27], s93 offen lds
    buffer_load_dwordx4 v27, s[24:27], s93 offen offset:1024 lds
    s_add_u32 m0, s61, 65536
    s_add_u32 s93, s93, 65536
    buffer_load_dwordx4 v26, s[24:27], s93 offen lds
    buffer_load_dwordx4 v27, s[24:27], s93 offen offset:1024 lds
    s_waitcnt lgkmcnt(8)
    v_pk_add_f32 v[64:65], v[64:65], v[80:81]
    v_pk_add_f32 v[66:67], v[66:67], v[82:83]
    v_pk_add_f32 v[68:69], v[68:69], v[84:85]
    v_pk_add_f32 v[70:71], v[70:71], v[86:87]
    v_pk_add_f32 v[72:73], v[72:73], v[88:89]
    v_pk_add_f32 v[74:75], v[74:75], v[90:91]
    v_pk_add_f32 v[76:77], v[76:77], v[92:93]
    v_pk_add_f32 v[78:79], v[78:79], v[94:95]
    s_waitcnt lgkmcnt(4)
    v_pk_add_f32 v[64:65], v[64:65], v[96:97]
    v_pk_add_f32 v[66:67], v[66:67], v[98:99]
    v_pk_add_f32 v[68:69], v[68:69], v[100:101]
    v_pk_add_f32 v[70:71], v[70:71], v[102:103]
    v_pk_add_f32 v[72:73], v[72:73], v[104:105]
    v_pk_add_f32 v[74:75], v[74:75], v[106:107]
    v_pk_add_f32 v[76:77], v[76:77], v[108:109]
    v_pk_add_f32 v[78:79], v[78:79], v[110:111]
    s_waitcnt lgkmcnt(0)
    v_pk_add_f32 v[64:65], v[64:65], v[112:113]
    v_pk_add_f32 v[66:67], v[66:67], v[114:115]
    v_pk_add_f32 v[68:69], v[68:69], v[116:117]
    v_pk_add_f32 v[70:71], v[70:71], v[118:119]
    v_pk_add_f32 v[72:73], v[72:73], v[120:121]
    v_pk_add_f32 v[74:75], v[74:75], v[122:123]
    v_pk_add_f32 v[76:77], v[76:77], v[124:125]
    v_pk_add_f32 v[78:79], v[78:79], v[126:127]
    s_mov_b32 s62, 0xbdd2d3e8
    s_mov_b32 s63, 0xbdd2d3e8
    v_pk_mul_f32 v[96:97], v[64:65], v[64:65]
    v_pk_mul_f32 v[98:99], v[66:67], v[66:67]
    v_pk_mul_f32 v[100:101], v[68:69], v[68:69]
    v_pk_mul_f32 v[102:103], v[70:71], v[70:71]
    v_pk_mul_f32 v[104:105], v[72:73], v[72:73]
    v_pk_mul_f32 v[106:107], v[74:75], v[74:75]
    v_pk_mul_f32 v[108:109], v[76:77], v[76:77]
    v_pk_mul_f32 v[110:111], v[78:79], v[78:79]
    v_pk_fma_f32 v[96:97], v[96:97], s[62:63], v[60:61]
    v_pk_fma_f32 v[98:99], v[98:99], s[62:63], v[60:61]
    v_pk_fma_f32 v[100:101], v[100:101], s[62:63], v[60:61]
    v_pk_fma_f32 v[102:103], v[102:103], s[62:63], v[60:61]
    v_pk_fma_f32 v[104:105], v[104:105], s[62:63], v[60:61]
    v_pk_fma_f32 v[106:107], v[106:107], s[62:63], v[60:61]
    v_pk_fma_f32 v[108:109], v[108:109], s[62:63], v[60:61]
    v_pk_fma_f32 v[110:111], v[110:111], s[62:63], v[60:61]
    v_pk_mul_f32 v[96:97], v[96:97], v[64:65]
    v_pk_mul_f32 v[98:99], v[98:99], v[66:67]
    v_pk_mul_f32 v[100:101], v[100:101], v[68:69]
    v_pk_mul_f32 v[102:103], v[102:103], v[70:71]
    v_pk_mul_f32 v[104:105], v[104:105], v[72:73]
    v_pk_mul_f32 v[106:107], v[106:107], v[74:75]
    v_pk_mul_f32 v[108:109], v[108:109], v[76:77]
    v_pk_mul_f32 v[110:111], v[110:111], v[78:79]
    v_exp_f32 v96, v96
    v_exp_f32 v97, v97
    v_exp_f32 v98, v98
    v_exp_f32 v99, v99
    v_exp_f32 v100, v100
    v_exp_f32 v101, v101
    v_exp_f32 v102, v102
    v_exp_f32 v103, v103
    v_exp_f32 v104, v104
    v_exp_f32 v105, v105
    v_exp_f32 v106, v106
    v_exp_f32 v107, v107
    v_exp_f32 v108, v108
    v_exp_f32 v109, v109
    v_exp_f32 v110, v110
    v_exp_f32 v111, v111
    v_pk_add_f32 v[96:97], v[96:97], v[62:63]
    v_pk_add_f32 v[98:99], v[98:99], v[62:63]
    v_pk_add_f32 v[100:101], v[100:101], v[62:63]
    v_pk_add_f32 v[102:103], v[102:103], v[62:63]
    v_pk_add_f32 v[104:105], v[104:105], v[62:63]
    v_pk_add_f32 v[106:107], v[106:107], v[62:63]
    v_pk_add_f32 v[108:109], v[108:109], v[62:63]
    v_pk_add_f32 v[110:111], v[110:111], v[62:63]
    v_rcp_f32 v96, v96
    v_rcp_f32 v97, v97
    v_rcp_f32 v98, v98
    v_rcp_f32 v99, v99
    v_rcp_f32 v100, v100
    v_rcp_f32 v101, v101
    v_rcp_f32 v102, v102
    v_rcp_f32 v103, v103
    v_rcp_f32 v104, v104
    v_rcp_f32 v105, v105
    v_rcp_f32 v106, v106
    v_rcp_f32 v107, v107
    v_rcp_f32 v108, v108
    v_rcp_f32 v109, v109
    v_rcp_f32 v110, v110
    v_rcp_f32 v111, v111
    v_pk_mul_f32 v[64:65], v[64:65], v[96:97]
    v_pk_mul_f32 v[66:67], v[66:67], v[98:99]
    v_pk_mul_f32 v[68:69], v[68:69], v[100:101]
    v_pk_mul_f32 v[70:71], v[70:71], v[102:103]
    v_pk_mul_f32 v[72:73], v[72:73], v[104:105]
    v_pk_mul_f32 v[74:75], v[74:75], v[106:107]
    v_pk_mul_f32 v[76:77], v[76:77], v[108:109]
    v_pk_mul_f32 v[78:79], v[78:79], v[110:111]
    v_cvt_pk_bf16_f32 v96, v64, v65
    v_cvt_pk_bf16_f32 v97, v66, v67
    v_cvt_pk_bf16_f32 v98, v68, v69
    v_cvt_pk_bf16_f32 v99, v70, v71
    v_cvt_pk_bf16_f32 v100, v72, v73
    v_cvt_pk_bf16_f32 v101, v74, v75
    v_cvt_pk_bf16_f32 v102, v76, v77
    v_cvt_pk_bf16_f32 v103, v78, v79
    v_permlane32_swap_b32 v96, v98
    v_permlane32_swap_b32 v97, v99
    v_permlane32_swap_b32 v100, v102
    v_permlane32_swap_b32 v101, v103
    s_mov_b32 s82, 0x900000
    buffer_store_dwordx4 v[96:99], v39, s[16:19], s82 offen sc1
    buffer_store_dwordx4 v[100:103], v39, s[16:19], s82 offen offset:2048 sc1
    s_waitcnt vmcnt(0)
    s_barrier
    s_cmp_lg_u32 s52, 0
    s_cbranch_scc1 PUB_10
    s_cmp_lg_u32 s95, 0
    s_cbranch_scc1 PUB_10
    s_lshl_b32 s62, s56, 7
    s_add_u32 s62, s62, 0x10000
    v_mov_b32 v2, s3
    s_mov_b64 exec, 1
    buffer_store_dword v2, off, s[16:19], s62 offset:0 sc1
    s_mov_b64 exec, -1
PUB_10:
    v_and_b32 v2, 31, v0
    s_lshl_b32 s62, s59, 6
    s_and_b32 s63, s52, 1
    s_lshl_b32 s63, s63, 5
    s_add_u32 s62, s62, s63
    v_add_u32 v2, s62, v2
    v_lshlrev_b32 v3, 1, v2
    v_mul_u32_u24 v2, 896, v2
    s_lshl_b32 s62, s60, 7
    s_lshr_b32 s63, s52, 1
    s_lshl_b32 s63, s63, 6
    s_add_u32 s62, s62, s63
    v_add_u32 v2, s62, v2
    v_bfe_u32 v4, v0, 5, 1
    v_lshl_add_u32 v44, v4, 4, v2
    buffer_load_ushort v45, v3, s[32:35], 0 offen
    s_mov_b32 s96, s46
    s_and_b32 s97, s47, 0xffff
    s_mov_b32 s98, 0x1c0000
    s_mov_b32 s99, 0x20000
    v_and_b32 v2, 63, v0
    s_mul_i32 s62, s52, 7
    v_add_u32 v3, s62, v2
    v_mul_u32_u24 v3, 7, v3
    v_add_u32 v3, s60, v3
    v_lshlrev_b32 v3, 7, v3
    v_add_u32 v3, 0x10000, v3
    v_cmp_gt_u32 vcc, 7, v2
    s_nop 1
    v_cndmask_b32 v42, v249, v3, vcc
    s_lshl_b32 s94, s91, 11
    s_add_u32 s94, s94, 0x900000
    ds_read_b64_tr_b16 a[48:49], v30 offset:24576
    ds_read_b64_tr_b16 a[50:51], v30 offset:25088
    ds_read_b64_tr_b16 a[52:53], v31 offset:24576
    ds_read_b64_tr_b16 a[54:55], v31 offset:25088
    s_add_u32 m0, s61, 73728
    s_add_u32 s93, s93, 65536
    buffer_load_dwordx4 v26, s[24:27], s93 offen lds
    buffer_load_dwordx4 v27, s[24:27], s93 offen offset:1024 lds
    ds_read_b64_tr_b16 a[56:57], v30 offset:32768
    ds_read_b64_tr_b16 a[58:59], v30 offset:33280
    ds_read_b64_tr_b16 a[60:61], v31 offset:32768
    ds_read_b64_tr_b16 a[62:63], v31 offset:33280
    s_add_u32 m0, s61, 106496
    s_add_u32 s93, s93, 65536
    buffer_load_dwordx4 v26, s[24:27], s93 offen lds
    buffer_load_dwordx4 v27, s[24:27], s93 offen offset:1024 lds
    ds_read_b64_tr_b16 a[64:65], v30 offset:40960
    ds_read_b64_tr_b16 a[66:67], v30 offset:41472
    ds_read_b64_tr_b16 a[68:69], v31 offset:40960
    ds_read_b64_tr_b16 a[70:71], v31 offset:41472
    s_add_u32 m0, s61, 0
    s_add_u32 s93, s93, 65536
    buffer_load_dwordx4 v26, s[24:27], s93 offen lds
    buffer_load_dwordx4 v27, s[24:27], s93 offen offset:1024 lds
    ds_read_b64_tr_b16 a[72:73], v28 offset:32768
    ds_read_b64_tr_b16 a[74:75], v28 offset:33280
    ds_read_b64_tr_b16 a[76:77], v29 offset:32768
    ds_read_b64_tr_b16 a[78:79], v29 offset:33280
    s_add_u32 m0, s61, 8192
    s_add_u32 s93, s93, 65536
    buffer_load_dwordx4 v26, s[24:27], s93 offen lds
    buffer_load_dwordx4 v27, s[24:27], s93 offen offset:1024 lds
    ds_read_b64_tr_b16 a[80:81], v28 offset:40960
    ds_read_b64_tr_b16 a[82:83], v28 offset:41472
    ds_read_b64_tr_b16 a[84:85], v29 offset:40960
    ds_read_b64_tr_b16 a[86:87], v29 offset:41472
    s_add_u32 m0, s61, 16384
    s_add_u32 s93, s93, 65536
    buffer_load_dwordx4 v26, s[24:27], s93 offen lds
    buffer_load_dwordx4 v27, s[24:27], s93 offen offset:1024 lds
    ds_read_b64_tr_b16 a[88:89], v28 offset:49152
    ds_read_b64_tr_b16 a[90:91], v28 offset:49664
    ds_read_b64_tr_b16 a[92:93], v29 offset:49152
    ds_read_b64_tr_b16 a[94:95], v29 offset:49664
    s_add_u32 m0, s61, 24576
    s_add_u32 s93, s93, 65536
    buffer_load_dwordx4 v26, s[24:27], s93 offen lds
    buffer_load_dwordx4 v27, s[24:27], s93 offen offset:1024 lds
    ds_read_b64_tr_b16 a[96:97], v30 offset:0
    ds_read_b64_tr_b16 a[98:99], v30 offset:512
    ds_read_b64_tr_b16 a[100:101], v31 offset:0
    ds_read_b64_tr_b16 a[102:103], v31 offset:512
    s_waitcnt lgkmcnt(0)
    s_add_u32 m0, s61, 81920
    s_add_u32 s93, s93, 65536
    buffer_load_dwordx4 v26, s[24:27], s93 offen lds
    buffer_load_dwordx4 v27, s[24:27], s93 offen offset:1024 lds
    ds_read_b64_tr_b16 a[104:105], v30 offset:8192
    ds_read_b64_tr_b16 a[106:107], v30 offset:8704
    ds_read_b64_tr_b16 a[108:109], v31 offset:8192
    ds_read_b64_tr_b16 a[110:111], v31 offset:8704
    s_add_u32 m0, s61, 90112
    s_add_u32 s93, s93, 65536
    buffer_load_dwordx4 v26, s[24:27], s93 offen lds
    buffer_load_dwordx4 v27, s[24:27], s93 offen offset:1024 lds
    s_waitcnt vmcnt(14)
    ds_read_b64_tr_b16 a[112:113], v30 offset:16384
    ds_read_b64_tr_b16 a[114:115], v30 offset:16896
    ds_read_b64_tr_b16 a[116:117], v31 offset:16384
    ds_read_b64_tr_b16 a[118:119], v31 offset:16896
    s_add_u32 m0, s61, 98304
    s_add_u32 s93, s93, 65536
    buffer_load_dwordx4 v26, s[24:27], s93 offen lds
    buffer_load_dwordx4 v27, s[24:27], s93 offen offset:1024 lds
    buffer_load_dword v46, v42, s[16:19], 0 offen sc1
    s_waitcnt vmcnt(15)
    ds_read_b64_tr_b16 a[120:121], v30 offset:49152
    ds_read_b64_tr_b16 a[122:123], v30 offset:49664
    ds_read_b64_tr_b16 a[124:125], v31 offset:49152
    ds_read_b64_tr_b16 a[126:127], v31 offset:49664
    s_add_u32 m0, s61, 32768
    s_add_u32 s93, s93, 65536
    buffer_load_dwordx4 v26, s[24:27], s93 offen lds
    buffer_load_dwordx4 v27, s[24:27], s93 offen offset:1024 lds
    s_waitcnt vmcnt(15)
    ds_read_b64_tr_b16 a[128:129], v28 offset:0
    ds_read_b64_tr_b16 a[130:131], v28 offset:512
    ds_read_b64_tr_b16 a[132:133], v29 offset:0
    ds_read_b64_tr_b16 a[134:135], v29 offset:512
    s_add_u32 m0, s61, 40960
    s_add_u32 s93, s93, 65536
    buffer_load_dwordx4 v26, s[24:27], s93 offen lds
    buffer_load_dwordx4 v27, s[24:27], s93 offen offset:1024 lds
    s_waitcnt vmcnt(15)
    ds_read_b64_tr_b16 a[136:137], v28 offset:8192
    ds_read_b64_tr_b16 a[138:139], v28 offset:8704
    ds_read_b64_tr_b16 a[140:141], v29 offset:8192
    ds_read_b64_tr_b16 a[142:143], v29 offset:8704
    s_add_u32 m0, s61, 49152
    s_add_u32 s93, s93, 65536
    buffer_load_dwordx4 v26, s[24:27], s93 offen lds
    buffer_load_dwordx4 v27, s[24:27], s93 offen offset:1024 lds
    s_waitcnt vmcnt(15)
    ds_read_b64_tr_b16 a[144:145], v28 offset:16384
    ds_read_b64_tr_b16 a[146:147], v28 offset:16896
    ds_read_b64_tr_b16 a[148:149], v29 offset:16384
    ds_read_b64_tr_b16 a[150:151], v29 offset:16896
    s_add_u32 m0, s61, 57344
    s_add_u32 s93, s93, 65536
    buffer_load_dwordx4 v26, s[24:27], s93 offen lds
    buffer_load_dwordx4 v27, s[24:27], s93 offen offset:1024 lds
    s_waitcnt vmcnt(15)
    ds_read_b64_tr_b16 a[152:153], v28 offset:24576
    ds_read_b64_tr_b16 a[154:155], v28 offset:25088
    ds_read_b64_tr_b16 a[156:157], v29 offset:24576
    ds_read_b64_tr_b16 a[158:159], v29 offset:25088
    s_waitcnt lgkmcnt(0)
    s_add_u32 m0, s61, 65536
    s_add_u32 s93, s93, 65536
    buffer_load_dwordx4 v26, s[24:27], s93 offen lds
    buffer_load_dwordx4 v27, s[24:27], s93 offen offset:1024 lds
    s_mov_b32 s80, 0
    s_waitcnt vmcnt(10)
    s_branch G5_11_chk
G5_11:
    buffer_load_dword v46, v42, s[16:19], 0 offen offset:0 sc1
    s_waitcnt vmcnt(0)
G5_11_chk:
    v_cmp_le_i32 vcc, 0, v42
    v_mov_b32 v47, s3
    s_nop 0
    v_cndmask_b32 v46, v47, v46, vcc
    v_cmp_ne_u32 vcc, s3, v46
    s_cbranch_vccz G5_11_ok
    s_add_u32 s80, s80, 1
    s_cmp_gt_u32 s80, 40000
    s_cbranch_scc1 G5_11_ok
    s_sleep 1
    s_branch G5_11
G5_11_ok:
    buffer_load_dwordx4 v[128:131], v34, s[16:19], s94 offen sc1
    buffer_load_dwordx4 v[132:135], v35, s[16:19], s94 offen sc1
    s_add_u32 s94, s94, 2048
    buffer_load_dwordx4 v[136:139], v34, s[16:19], s94 offen sc1
    buffer_load_dwordx4 v[140:143], v35, s[16:19], s94 offen sc1
    s_add_u32 s94, s94, 2048
    buffer_load_dwordx4 v[144:147], v34, s[16:19], s94 offen sc1
    buffer_load_dwordx4 v[148:151], v35, s[16:19], s94 offen sc1
    s_add_u32 s94, s94, 2048
    buffer_load_dwordx4 v[152:155], v34, s[16:19], s94 offen sc1
    buffer_load_dwordx4 v[156:159], v35, s[16:19], s94 offen sc1
    s_add_u32 s94, s94, 2048
    buffer_load_dwordx4 v[160:163], v34, s[16:19], s94 offen sc1
    buffer_load_dwordx4 v[164:167], v35, s[16:19], s94 offen sc1
    s_add_u32 s94, s94, 2048
    s_mov_b32 s81, 0x500000
    buffer_load_dwordx4 v[48:51], v44, s[16:19], s81 offen sc1
    buffer_load_dwordx4 v[52:55], v44, s[16:19], s81 offen offset:32 sc1
    s_waitcnt vmcnt(10)
    v_mfma_f32_32x32x16_bf16 v[64:79], v[128:131], a[0:3], 0
    buffer_load_dwordx4 v[168:171], v34, s[16:19], s94 offen sc1
    buffer_load_dwordx4 v[172:175], v35, s[16:19], s94 offen sc1
    s_add_u32 s94, s94, 2048
    v_mfma_f32_32x32x16_bf16 v[80:95], v[128:131], a[4:7], 0
    v_mfma_f32_32x32x16_bf16 v[96:111], v[132:135], a[0:3], 0
    v_mfma_f32_32x32x16_bf16 v[112:127], v[132:135], a[4:7], 0
    s_waitcnt vmcnt(10)
    v_mfma_f32_32x32x16_bf16 v[64:79], v[136:139], a[8:11], v[64:79]
    buffer_load_dwordx4 v[176:179], v34, s[16:19], s94 offen sc1
    buffer_load_dwordx4 v[180:183], v35, s[16:19], s94 offen sc1
    s_add_u32 s94, s94, 2048
    v_mfma_f32_32x32x16_bf16 v[80:95], v[136:139], a[12:15], v[80:95]
    v_mfma_f32_32x32x16_bf16 v[96:111], v[140:143], a[8:11], v[96:111]
    v_mfma_f32_32x32x16_bf16 v[112:127], v[140:143], a[12:15], v[112:127]
    s_waitcnt vmcnt(10)
    v_mfma_f32_32x32x16_bf16 v[64:79], v[144:147], a[16:19], v[64:79]
    buffer_load_dwordx4 v[184:187], v34, s[16:19], s94 offen sc1
    buffer_load_dwordx4 v[188:191], v35, s[16:19], s94 offen sc1
    s_add_u32 s94, s94, 2048
    v_mfma_f32_32x32x16_bf16 v[80:95], v[144:147], a[20:23], v[80:95]
    v_mfma_f32_32x32x16_bf16 v[96:111], v[148:151], a[16:19], v[96:111]
    v_mfma_f32_32x32x16_bf16 v[112:127], v[148:151], a[20:23], v[112:127]
    s_waitcnt vmcnt(10)
    v_mfma_f32_32x32x16_bf16 v[64:79], v[152:155], a[24:27], v[64:79]
    buffer_load_dwordx4 v[128:131], v34, s[16:19], s94 offen sc1
    buffer_load_dwordx4 v[132:135], v35, s[16:19], s94 offen sc1
    s_add_u32 s94, s94, 2048
    v_mfma_f32_32x32x16_bf16 v[80:95], v[152:155], a[28:31], v[80:95]
    v_mfma_f32_32x32x16_bf16 v[96:111], v[156:159], a[24:27], v[96:111]
    v_mfma_f32_32x32x16_bf16 v[112:127], v[156:159], a[28:31], v[112:127]
    s_waitcnt vmcnt(10)
    v_mfma_f32_32x32x16_bf16 v[64:79], v[160:163], a[32:35], v[64:79]
    buffer_load_dwordx4 v[136:139], v34, s[16:19], s94 offen sc1
    buffer_load_dwordx4 v[140:143], v35, s[16:19], s94 offen sc1
    s_add_u32 s94, s94, 2048
    v_mfma_f32_32x32x16_bf16 v[80:95], v[160:163], a[36:39], v[80:95]
    v_mfma_f32_32x32x16_bf16 v[96:111], v[164:167], a[32:35], v[96:111]
    v_mfma_f32_32x32x16_bf16 v[112:127], v[164:167], a[36:39], v[112:127]
    s_waitcnt vmcnt(8)
    v_mfma_f32_32x32x16_bf16 v[64:79], v[168:171], a[40:43], v[64:79]
    buffer_load_dwordx4 v[144:147], v34, s[16:19], s94 offen sc1
    buffer_load_dwordx4 v[148:151], v35, s[16:19], s94 offen sc1
    s_add_u32 s94, s94, 2048
    v_mfma_f32_32x32x16_bf16 v[80:95], v[168:171], a[44:47], v[80:95]
    v_mfma_f32_32x32x16_bf16 v[96:111], v[172:175], a[40:43], v[96:111]
    v_mfma_f32_32x32x16_bf16 v[112:127], v[172:175], a[44:47], v[112:127]
    s_waitcnt vmcnt(8)
    v_mfma_f32_32x32x16_bf16 v[64:79], v[176:179], a[48:51], v[64:79]
    buffer_load_dwordx4 v[152:155], v34, s[16:19], s94 offen sc1
    buffer_load_dwordx4 v[156:159], v35, s[16:19], s94 offen sc1
    s_add_u32 s94, s94, 2048
    v_mfma_f32_32x32x16_bf16 v[80:95], v[176:179], a[52:55], v[80:95]
    v_mfma_f32_32x32x16_bf16 v[96:111], v[180:183], a[48:51], v[96:111]
    v_mfma_f32_32x32x16_bf16 v[112:127], v[180:183], a[52:55], v[112:127]
    s_waitcnt vmcnt(8)
    v_mfma_f32_32x32x16_bf16 v[64:79], v[184:187], a[56:59], v[64:79]
    buffer_load_dwordx4 v[160:163], v34, s[16:19], s94 offen sc1
    buffer_load_dwordx4 v[164:167], v35, s[16:19], s94 offen sc1
    s_add_u32 s94, s94, 2048
    v_mfma_f32_32x32x16_bf16 v[80:95], v[184:187], a[60:63], v[80:95]
    v_mfma_f32_32x32x16_bf16 v[96:111], v[188:191], a[56:59], v[96:111]
    v_mfma_f32_32x32x16_bf16 v[112:127], v[188:191], a[60:63], v[112:127]
    s_waitcnt vmcnt(8)
    v_mfma_f32_32x32x16_bf16 v[64:79], v[128:131], a[64:67], v[64:79]
    buffer_load_dwordx4 v[168:171], v34, s[16:19], s94 offen sc1
    buffer_load_dwordx4 v[172:175], v35, s[16:19], s94 offen sc1
    s_add_u32 s94, s94, 2048
    v_mfma_f32_32x32x16_bf16 v[80:95], v[128:131], a[68:71], v[80:95]
    v_mfma_f32_32x32x16_bf16 v[96:111], v[132:135], a[64:67], v[96:111]
    v_mfma_f32_32x32x16_bf16 v[112:127], v[132:135], a[68:71], v[112:127]
    s_waitcnt vmcnt(8)
    v_mfma_f32_32x32x16_bf16 v[64:79], v[136:139], a[72:75], v[64:79]
    buffer_load_dwordx4 v[176:179], v34, s[16:19], s94 offen sc1
    buffer_load_dwordx4 v[180:183], v35, s[16:19], s94 offen sc1
    s_add_u32 s94, s94, 2048
    v_mfma_f32_32x32x16_bf16 v[80:95], v[136:139], a[76:79], v[80:95]
    v_mfma_f32_32x32x16_bf16 v[96:111], v[140:143], a[72:75], v[96:111]
    v_mfma_f32_32x32x16_bf16 v[112:127], v[140:143], a[76:79], v[112:127]
    v_permlane32_swap_b32 v48, v50
    v_permlane32_swap_b32 v49, v51
    v_permlane32_swap_b32 v52, v54
    v_permlane32_swap_b32 v53, v55
    v_lshlrev_b32 v46, 16, v45
    v_lshlrev_b32 v47, 16, v45
    v_lshlrev_b32 v192, 16, v48
    v_and_b32 v193, 0xffff0000, v48
    v_lshlrev_b32 v194, 16, v49
    v_and_b32 v195, 0xffff0000, v49
    v_lshlrev_b32 v196, 16, v50
    v_and_b32 v197, 0xffff0000, v50
    v_lshlrev_b32 v198, 16, v51
    v_and_b32 v199, 0xffff0000, v51
    v_lshlrev_b32 v200, 16, v52
    v_and_b32 v201, 0xffff0000, v52
    v_lshlrev_b32 v202, 16, v53
    v_and_b32 v203, 0xffff0000, v53
    v_lshlrev_b32 v204, 16, v54
    v_and_b32 v205, 0xffff0000, v54
    v_lshlrev_b32 v206, 16, v55
    v_and_b32 v207, 0xffff0000, v55
    v_pk_add_f32 v[192:193], v[192:193], v[46:47]
    v_pk_add_f32 v[194:195], v[194:195], v[46:47]
    v_pk_add_f32 v[196:197], v[196:197], v[46:47]
    v_pk_add_f32 v[198:199], v[198:199], v[46:47]
    v_pk_add_f32 v[200:201], v[200:201], v[46:47]
    v_pk_add_f32 v[202:203], v[202:203], v[46:47]
    v_pk_add_f32 v[204:205], v[204:205], v[46:47]
    v_pk_add_f32 v[206:207], v[206:207], v[46:47]
    v_pk_add_f32 v[64:65], v[64:65], v[192:193]
    v_pk_add_f32 v[66:67], v[66:67], v[194:195]
    v_pk_add_f32 v[68:69], v[68:69], v[196:197]
    v_pk_add_f32 v[70:71], v[70:71], v[198:199]
    v_pk_add_f32 v[72:73], v[72:73], v[200:201]
    v_pk_add_f32 v[74:75], v[74:75], v[202:203]
    v_pk_add_f32 v[76:77], v[76:77], v[204:205]
    v_pk_add_f32 v[78:79], v[78:79], v[206:207]
    s_waitcnt vmcnt(8)
    s_nop 0
    v_mfma_f32_32x32x16_bf16 v[64:79], v[144:147], a[80:83], v[64:79]
    buffer_load_dwordx4 v[184:187], v34, s[16:19], s94 offen sc1
    buffer_load_dwordx4 v[188:191], v35, s[16:19], s94 offen sc1
    s_add_u32 s94, s94, 2048
    v_mfma_f32_32x32x16_bf16 v[80:95], v[144:147], a[84:87], v[80:95]
    v_mfma_f32_32x32x16_bf16 v[96:111], v[148:151], a[80:83], v[96:111]
    v_mfma_f32_32x32x16_bf16 v[112:127], v[148:151], a[84:87], v[112:127]
    s_waitcnt vmcnt(8)
    v_mfma_f32_32x32x16_bf16 v[64:79], v[152:155], a[88:91], v[64:79]
    buffer_load_dwordx4 v[128:131], v34, s[16:19], s94 offen sc1
    buffer_load_dwordx4 v[132:135], v35, s[16:19], s94 offen sc1
    s_add_u32 s94, s94, 2048
    v_mfma_f32_32x32x16_bf16 v[80:95], v[152:155], a[92:95], v[80:95]
    v_mfma_f32_32x32x16_bf16 v[96:111], v[156:159], a[88:91], v[96:111]
    v_mfma_f32_32x32x16_bf16 v[112:127], v[156:159], a[92:95], v[112:127]
    s_waitcnt vmcnt(8)
    v_mfma_f32_32x32x16_bf16 v[64:79], v[160:163], a[96:99], v[64:79]
    buffer_load_dwordx4 v[136:139], v34, s[16:19], s94 offen sc1
    buffer_load_dwordx4 v[140:143], v35, s[16:19], s94 offen sc1
    s_add_u32 s94, s94, 2048
    v_mfma_f32_32x32x16_bf16 v[80:95], v[160:163], a[100:103], v[80:95]
    v_mfma_f32_32x32x16_bf16 v[96:111], v[164:167], a[96:99], v[96:111]
    v_mfma_f32_32x32x16_bf16 v[112:127], v[164:167], a[100:103], v[112:127]
    s_waitcnt vmcnt(8)
    v_mfma_f32_32x32x16_bf16 v[64:79], v[168:171], a[104:107], v[64:79]
    buffer_load_dwordx4 v[144:147], v34, s[16:19], s94 offen sc1
    buffer_load_dwordx4 v[148:151], v35, s[16:19], s94 offen sc1
    s_add_u32 s94, s94, 2048
    v_mfma_f32_32x32x16_bf16 v[80:95], v[168:171], a[108:111], v[80:95]
    v_mfma_f32_32x32x16_bf16 v[96:111], v[172:175], a[104:107], v[96:111]
    v_mfma_f32_32x32x16_bf16 v[112:127], v[172:175], a[108:111], v[112:127]
    s_waitcnt vmcnt(8)
    v_mfma_f32_32x32x16_bf16 v[64:79], v[176:179], a[112:115], v[64:79]
    buffer_load_dwordx4 v[152:155], v34, s[16:19], s94 offen sc1
    buffer_load_dwordx4 v[156:159], v35, s[16:19], s94 offen sc1
    s_add_u32 s94, s94, 2048
    v_mfma_f32_32x32x16_bf16 v[80:95], v[176:179], a[116:119], v[80:95]
    v_mfma_f32_32x32x16_bf16 v[96:111], v[180:183], a[112:115], v[96:111]
    v_mfma_f32_32x32x16_bf16 v[112:127], v[180:183], a[116:119], v[112:127]
    s_waitcnt vmcnt(8)
    v_mfma_f32_32x32x16_bf16 v[64:79], v[184:187], a[120:123], v[64:79]
    buffer_load_dwordx4 v[160:163], v34, s[16:19], s94 offen sc1
    buffer_load_dwordx4 v[164:167], v35, s[16:19], s94 offen sc1
    s_add_u32 s94, s94, 2048
    v_mfma_f32_32x32x16_bf16 v[80:95], v[184:187], a[124:127], v[80:95]
    v_mfma_f32_32x32x16_bf16 v[96:111], v[188:191], a[120:123], v[96:111]
    v_mfma_f32_32x32x16_bf16 v[112:127], v[188:191], a[124:127], v[112:127]
    s_waitcnt vmcnt(8)
    v_mfma_f32_32x32x16_bf16 v[64:79], v[128:131], a[128:131], v[64:79]
    buffer_load_dwordx4 v[168:171], v34, s[16:19], s94 offen sc1
    buffer_load_dwordx4 v[172:175], v35, s[16:19], s94 offen sc1
    s_add_u32 s94, s94, 2048
    v_mfma_f32_32x32x16_bf16 v[80:95], v[128:131], a[132:135], v[80:95]
    v_mfma_f32_32x32x16_bf16 v[96:111], v[132:135], a[128:131], v[96:111]
    v_mfma_f32_32x32x16_bf16 v[112:127], v[132:135], a[132:135], v[112:127]
    s_waitcnt vmcnt(8)
    v_mfma_f32_32x32x16_bf16 v[64:79], v[136:139], a[136:139], v[64:79]
    buffer_load_dwordx4 v[176:179], v34, s[16:19], s94 offen sc1
    buffer_load_dwordx4 v[180:183], v35, s[16:19], s94 offen sc1
    s_add_u32 s94, s94, 2048
    v_mfma_f32_32x32x16_bf16 v[80:95], v[136:139], a[140:143], v[80:95]
    v_mfma_f32_32x32x16_bf16 v[96:111], v[140:143], a[136:139], v[96:111]
    v_mfma_f32_32x32x16_bf16 v[112:127], v[140:143], a[140:143], v[112:127]
    s_waitcnt vmcnt(8)
    v_mfma_f32_32x32x16_bf16 v[64:79], v[144:147], a[144:147], v[64:79]
    buffer_load_dwordx4 v[184:187], v34, s[16:19], s94 offen sc1
    buffer_load_dwordx4 v[188:191], v35, s[16:19], s94 offen sc1
    s_add_u32 s94, s94, 2048
    ds_read_b64_tr_b16 a[160:161], v30 offset:24576
    ds_read_b64_tr_b16 a[162:163], v30 offset:25088
    ds_read_b64_tr_b16 a[164:165], v31 offset:24576
    ds_read_b64_tr_b16 a[166:167], v31 offset:25088
    v_mfma_f32_32x32x16_bf16 v[80:95], v[144:147], a[148:151], v[80:95]
    v_mfma_f32_32x32x16_bf16 v[96:111], v[148:151], a[144:147], v[96:111]
    v_mfma_f32_32x32x16_bf16 v[112:127], v[148:151], a[148:151], v[112:127]
    s_waitcnt vmcnt(8)
    v_mfma_f32_32x32x16_bf16 v[64:79], v[152:155], a[152:155], v[64:79]
    buffer_load_dwordx4 v[128:131], v34, s[16:19], s94 offen sc1
    buffer_load_dwordx4 v[132:135], v35, s[16:19], s94 offen sc1
    s_add_u32 s94, s94, 2048
    ds_read_b64_tr_b16 a[168:169], v30 offset:32768
    ds_read_b64_tr_b16 a[170:171], v30 offset:33280
    ds_read_b64_tr_b16 a[172:173], v31 offset:32768
    ds_read_b64_tr_b16 a[174:175], v31 offset:33280
    v_mfma_f32_32x32x16_bf16 v[80:95], v[152:155], a[156:159], v[80:95]
    v_mfma_f32_32x32x16_bf16 v[96:111], v[156:159], a[152:155], v[96:111]
    v_mfma_f32_32x32x16_bf16 v[112:127], v[156:159], a[156:159], v[112:127]
    s_waitcnt vmcnt(8)
    s_waitcnt lgkmcnt(4)
    v_mfma_f32_32x32x16_bf16 v[64:79], v[160:163], a[160:163], v[64:79]
    buffer_load_dwordx4 v[136:139], v34, s[16:19], s94 offen sc1
    buffer_load_dwordx4 v[140:143], v35, s[16:19], s94 offen sc1
    s_add_u32 s94, s94, 2048
    ds_read_b64_tr_b16 a[176:177], v30 offset:40960
    ds_read_b64_tr_b16 a[178:179], v30 offset:41472
    ds_read_b64_tr_b16 a[180:181], v31 offset:40960
    ds_read_b64_tr_b16 a[182:183], v31 offset:41472
    v_mfma_f32_32x32x16_bf16 v[80:95], v[160:163], a[164:167], v[80:95]
    v_mfma_f32_32x32x16_bf16 v[96:111], v[164:167], a[160:163], v[96:111]
    v_mfma_f32_32x32x16_bf16 v[112:127], v[164:167], a[164:167], v[112:127]
    s_waitcnt vmcnt(8)
    s_waitcnt lgkmcnt(4)
    v_mfma_f32_32x32x16_bf16 v[64:79], v[168:171], a[168:171], v[64:79]
    buffer_load_dwordx4 v[144:147], v34, s[16:19], s94 offen sc1
    buffer_load_dwordx4 v[148:151], v35, s[16:19], s94 offen sc1
    s_add_u32 s94, s94, 2048
    ds_read_b64_tr_b16 a[184:185], v28 offset:32768
    ds_read_b64_tr_b16 a[186:187], v28 offset:33280
    ds_read_b64_tr_b16 a[188:189], v29 offset:32768
    ds_read_b64_tr_b16 a[190:191], v29 offset:33280
    v_mfma_f32_32x32x16_bf16 v[80:95], v[168:171], a[172:175], v[80:95]
    v_mfma_f32_32x32x16_bf16 v[96:111], v[172:175], a[168:171], v[96:111]
    v_mfma_f32_32x32x16_bf16 v[112:127], v[172:175], a[172:175], v[112:127]
    s_waitcnt vmcnt(8)
    s_waitcnt lgkmcnt(4)
    v_mfma_f32_32x32x16_bf16 v[64:79], v[176:179], a[176:179], v[64:79]
    buffer_load_dwordx4 v[152:155], v34, s[16:19], s94 offen sc1
    buffer_load_dwordx4 v[156:159], v35, s[16:19], s94 offen sc1
    s_add_u32 s94, s94, 2048
    ds_read_b64_tr_b16 a[192:193], v28 offset:40960
    ds_read_b64_tr_b16 a[194:195], v28 offset:41472
    ds_read_b64_tr_b16 a[196:197], v29 offset:40960
    ds_read_b64_tr_b16 a[198:199], v29 offset:41472
    v_mfma_f32_32x32x16_bf16 v[80:95], v[176:179], a[180:183], v[80:95]
    v_mfma_f32_32x32x16_bf16 v[96:111], v[180:183], a[176:179], v[96:111]
    v_mfma_f32_32x32x16_bf16 v[112:127], v[180:183], a[180:183], v[112:127]
    s_waitcnt vmcnt(8)
    s_waitcnt lgkmcnt(4)
    v_mfma_f32_32x32x16_bf16 v[64:79], v[184:187], a[184:187], v[64:79]
    ds_read_b64_tr_b16 a[200:201], v28 offset:49152
    ds_read_b64_tr_b16 a[202:203], v28 offset:49664
    ds_read_b64_tr_b16 a[204:205], v29 offset:49152
    ds_read_b64_tr_b16 a[206:207], v29 offset:49664
    v_mfma_f32_32x32x16_bf16 v[80:95], v[184:187], a[188:191], v[80:95]
    v_mfma_f32_32x32x16_bf16 v[96:111], v[188:191], a[184:187], v[96:111]
    v_mfma_f32_32x32x16_bf16 v[112:127], v[188:191], a[188:191], v[112:127]
    s_waitcnt vmcnt(6)
    s_waitcnt lgkmcnt(4)
    v_mfma_f32_32x32x16_bf16 v[64:79], v[128:131], a[192:195], v[64:79]
    ds_read_b64_tr_b16 a[208:209], v30 offset:0
    ds_read_b64_tr_b16 a[210:211], v30 offset:512
    ds_read_b64_tr_b16 a[212:213], v31 offset:0
    ds_read_b64_tr_b16 a[214:215], v31 offset:512
    v_mfma_f32_32x32x16_bf16 v[80:95], v[128:131], a[196:199], v[80:95]
    v_mfma_f32_32x32x16_bf16 v[96:111], v[132:135], a[192:195], v[96:111]
    v_mfma_f32_32x32x16_bf16 v[112:127], v[132:135], a[196:199], v[112:127]
    s_waitcnt vmcnt(4)
    s_waitcnt lgkmcnt(4)
    v_mfma_f32_32x32x16_bf16 v[64:79], v[136:139], a[200:203], v[64:79]
    ds_read_b64_tr_b16 a[216:217], v30 offset:8192
    ds_read_b64_tr_b16 a[218:219], v30 offset:8704
    ds_read_b64_tr_b16 a[220:221], v31 offset:8192
    ds_read_b64_tr_b16 a[222:223], v31 offset:8704
    v_mfma_f32_32x32x16_bf16 v[80:95], v[136:139], a[204:207], v[80:95]
    v_mfma_f32_32x32x16_bf16 v[96:111], v[140:143], a[200:203], v[96:111]
    v_mfma_f32_32x32x16_bf16 v[112:127], v[140:143], a[204:207], v[112:127]
    s_waitcnt vmcnt(2)
    s_waitcnt lgkmcnt(4)
    v_mfma_f32_32x32x16_bf16 v[64:79], v[144:147], a[208:211], v[64:79]
    v_mfma_f32_32x32x16_bf16 v[80:95], v[144:147], a[212:215], v[80:95]
    v_mfma_f32_32x32x16_bf16 v[96:111], v[148:151], a[208:211], v[96:111]
    v_mfma_f32_32x32x16_bf16 v[112:127], v[148:151], a[212:215], v[112:127]
    s_waitcnt vmcnt(0)
    s_waitcnt lgkmcnt(0)
    v_mfma_f32_32x32x16_bf16 v[64:79], v[152:155], a[216:219], v[64:79]
    v_mfma_f32_32x32x16_bf16 v[80:95], v[152:155], a[220:223], v[80:95]
    v_mfma_f32_32x32x16_bf16 v[96:111], v[156:159], a[216:219], v[96:111]
    v_mfma_f32_32x32x16_bf16 v[112:127], v[156:159], a[220:223], v[112:127]
    s_nop 9
    ds_write_b128 v57, v[80:83] offset:0
    ds_write_b128 v57, v[84:87] offset:1024
    ds_write_b128 v57, v[88:91] offset:2048
    ds_write_b128 v57, v[92:95] offset:3072
    ds_write_b128 v58, v[96:99] offset:4096
    ds_write_b128 v58, v[100:103] offset:5120
    ds_write_b128 v58, v[104:107] offset:6144
    ds_write_b128 v58, v[108:111] offset:7168
    ds_write_b128 v59, v[112:115] offset:8192
    ds_write_b128 v59, v[116:119] offset:9216
    ds_write_b128 v59, v[120:123] offset:10240
    ds_write_b128 v59, v[124:127] offset:11264
    s_waitcnt lgkmcnt(0)
    s_barrier
    ds_read_b128 v[80:83], v56 offset:0
    ds_read_b128 v[84:87], v56 offset:1024
    ds_read_b128 v[88:91], v56 offset:2048
    ds_read_b128 v[92:95], v56 offset:3072
    ds_read_b128 v[96:99], v56 offset:4096
    ds_read_b128 v[100:103], v56 offset:5120
    ds_read_b128 v[104:107], v56 offset:6144
    ds_read_b128 v[108:111], v56 offset:7168
    ds_read_b128 v[112:115], v56 offset:8192
    ds_read_b128 v[116:119], v56 offset:9216
    ds_read_b128 v[120:123], v56 offset:10240
    ds_read_b128 v[124:127], v56 offset:11264
    s_waitcnt lgkmcnt(8)
    v_pk_add_f32 v[64:65], v[64:65], v[80:81]
    v_pk_add_f32 v[66:67], v[66:67], v[82:83]
    v_pk_add_f32 v[68:69], v[68:69], v[84:85]
    v_pk_add_f32 v[70:71], v[70:71], v[86:87]
    v_pk_add_f32 v[72:73], v[72:73], v[88:89]
    v_pk_add_f32 v[74:75], v[74:75], v[90:91]
    v_pk_add_f32 v[76:77], v[76:77], v[92:93]
    v_pk_add_f32 v[78:79], v[78:79], v[94:95]
    s_waitcnt lgkmcnt(4)
    v_pk_add_f32 v[64:65], v[64:65], v[96:97]
    v_pk_add_f32 v[66:67], v[66:67], v[98:99]
    v_pk_add_f32 v[68:69], v[68:69], v[100:101]
    v_pk_add_f32 v[70:71], v[70:71], v[102:103]
    v_pk_add_f32 v[72:73], v[72:73], v[104:105]
    v_pk_add_f32 v[74:75], v[74:75], v[106:107]
    v_pk_add_f32 v[76:77], v[76:77], v[108:109]
    v_pk_add_f32 v[78:79], v[78:79], v[110:111]
    s_waitcnt lgkmcnt(0)
    v_pk_add_f32 v[64:65], v[64:65], v[112:113]
    v_pk_add_f32 v[66:67], v[66:67], v[114:115]
    v_pk_add_f32 v[68:69], v[68:69], v[116:117]
    v_pk_add_f32 v[70:71], v[70:71], v[118:119]
    v_pk_add_f32 v[72:73], v[72:73], v[120:121]
    v_pk_add_f32 v[74:75], v[74:75], v[122:123]
    v_pk_add_f32 v[76:77], v[76:77], v[124:125]
    v_pk_add_f32 v[78:79], v[78:79], v[126:127]
    v_cvt_pk_bf16_f32 v96, v64, v65
    v_cvt_pk_bf16_f32 v97, v66, v67
    v_cvt_pk_bf16_f32 v98, v68, v69
    v_cvt_pk_bf16_f32 v99, v70, v71
    v_cvt_pk_bf16_f32 v100, v72, v73
    v_cvt_pk_bf16_f32 v101, v74, v75
    v_cvt_pk_bf16_f32 v102, v76, v77
    v_cvt_pk_bf16_f32 v103, v78, v79
    v_permlane32_swap_b32 v96, v98
    v_permlane32_swap_b32 v97, v99
    v_permlane32_swap_b32 v100, v102
    v_permlane32_swap_b32 v101, v103
    buffer_store_dwordx4 v[96:99], v44, s[96:99], 0 offen
    buffer_store_dwordx4 v[100:103], v44, s[96:99], 0 offen offset:32
    s_branch FIN
CPATH:
    s_and_b32 s53, s2, 7
    s_lshr_b32 s54, s2, 3
    s_lshl_b32 s55, s53, 5
    s_add_u32 s55, s55, s54
    s_mul_i32 s57, s54, 9363
    s_lshr_b32 s57, s57, 16
    s_mul_i32 s58, s57, 7
    s_sub_u32 s58, s54, s58
    s_mul_i32 s62, s53, 3
    s_min_u32 s81, s53, 4
    s_add_u32 s62, s62, s81
    s_add_u32 s57, s57, s62
    s_mul_i32 s56, s57, 7
    s_add_u32 s56, s56, s58
    s_cmp_lt_u32 s53, 4
    s_cselect_b32 s62, 28, 21
    s_cmp_lt_u32 s54, s62
    s_cselect_b32 s95, 0, 0x80000000
    s_mul_i32 s59, s54, 9363
    s_lshr_b32 s59, s59, 16
    s_mul_i32 s60, s59, 7
    s_sub_u32 s60, s54, s60
    s_lshl_b32 s62, s53, 2
    s_add_u32 s59, s62, s59
    s_and_b32 s62, s57, 3
    s_mul_i32 s62, s62, 0
    s_mul_i32 s63, s58, 5
    s_add_u32 s62, s62, s63
    s_and_b32 s90, s62, 31
    s_and_b32 s62, s59, 3
    s_mul_i32 s62, s62, 0
    s_lshl_b32 s63, s60, 2
    s_add_u32 s62, s62, s63
    s_cmp_ge_u32 s62, 28
    s_cselect_b32 s63, 28, 0
    s_sub_u32 s91, s62, s63
    s_lshl_b32 s62, s58, 5
    s_add_u32 s62, s62, 3
    s_mul_i32 s62, s62, 9363
    s_lshr_b32 s90, s62, 16
    s_mov_b32 s91, 0
    s_mul_i32 s92, s90, 57344
    s_sub_u32 s92, s92, 57344
    s_mul_i32 s93, s91, 65536
    s_sub_u32 s93, s93, 65536
    v_and_b32 v1, 63, v0
    v_lshrrev_b32 v2, 1, v1
    v_and_b32 v3, 1, v1
    v_lshl_add_u32 v4, v3, 5, v2
    s_lshl_b32 s62, s52, 6
    v_add_u32 v4, s62, v4
    s_mul_i32 s63, s55, 7168
    v_lshl_add_u32 v5, v4, 2, s63
    v_cmp_gt_u32 vcc, 224, v4
    s_nop 1
    v_cndmask_b32 v37, v249, v5, vcc
    v_add_u32 v2, s62, v2
    v_mul_u32_u24 v2, 8192, v2
    v_lshl_add_u32 v2, v3, 4, v2
    s_lshl_b32 s81, s55, 5
    v_add_u32 v36, s81, v2
    s_cmp_lt_u32 s52, 3
    s_mov_b32 s81, 262144
    s_cselect_b32 s81, s81, 0x80000000
    v_add_u32 v241, s81, v36
    s_lshr_b32 s63, s55, 6
    s_mul_i32 s63, s63, 65536
    s_bfe_u32 s81, s55, 0x50001
    s_lshl_b32 s81, s81, 11
    s_add_u32 s63, s63, s81
    s_and_b32 s81, s55, 1
    s_lshl_b32 s81, s81, 9
    s_add_u32 s63, s63, s81
    s_mul_i32 s81, s52, 524288
    s_add_u32 s63, s63, s81
    v_lshrrev_b32 v2, 5, v1
    v_lshlrev_b32 v2, 10, v2
    v_and_b32 v3, 31, v1
    v_lshl_add_u32 v2, v3, 4, v2
    v_add_u32 v38, s63, v2
    s_cmp_lt_u32 s52, 3
    s_mov_b32 s81, 262144
    s_cselect_b32 s81, s81, 0x80000000
    v_add_u32 v242, s81, v38
    v_bfe_u32 v2, v0, 4, 1
    v_lshlrev_b32 v2, 5, v2
    v_bfe_u32 v3, v0, 5, 1
    v_lshl_add_u32 v2, v3, 4, v2
    s_lshl_b32 s81, s52, 2
    v_add_u32 v243, s81, v2
    v_and_b32 v2, 7, v0
    v_lshlrev_b32 v244, 5, v2
    s_mov_b32 s68, s4
    s_and_b32 s69, s5, 0xffff
    s_mov_b32 s70, 0x1c0000
    s_mov_b32 s71, 0x20000
    s_movk_i32 s62, 4480
    buffer_load_dword v8, v37, s[68:71], 0 offen offset:0 nt
    buffer_load_dword v9, v37, s[68:71], 0 offen offset:896 nt
    buffer_load_dword v10, v37, s[68:71], 0 offen offset:1792 nt
    buffer_load_dword v11, v37, s[68:71], 0 offen offset:2688 nt
    buffer_load_dword v12, v37, s[68:71], 0 offen offset:3584 nt
    buffer_load_dword v13, v37, s[68:71], s62 offen offset:0 nt
    buffer_load_dword v14, v37, s[68:71], s62 offen offset:896 nt
    buffer_load_dword v15, v37, s[68:71], s62 offen offset:1792 nt
    s_waitcnt vmcnt(0)
    v_readfirstlane_b32 s3, v151
    s_add_u32 s3, s3, 0x9e3779b9
    s_barrier
    s_cmp_lg_u32 s52, 0
    s_cbranch_scc1 PUB_12
    s_lshl_b32 s62, s2, 7
    v_mov_b32 v2, s3
    s_mov_b64 exec, 1
    buffer_store_dword v2, off, s[16:19], s62 offset:8 sc1
    s_mov_b64 exec, -1
PUB_12:
    s_mov_b32 s62, 0x3f803f80
    v_dot2_f32_bf16 v208, v8, s62, 0
    v_dot2_f32_bf16 v209, v8, v8, 0
    v_dot2_f32_bf16 v210, v9, s62, 0
    v_dot2_f32_bf16 v211, v9, v9, 0
    v_dot2_f32_bf16 v212, v10, s62, 0
    v_dot2_f32_bf16 v213, v10, v10, 0
    v_dot2_f32_bf16 v214, v11, s62, 0
    v_dot2_f32_bf16 v215, v11, v11, 0
    v_dot2_f32_bf16 v216, v12, s62, 0
    v_dot2_f32_bf16 v217, v12, v12, 0
    v_dot2_f32_bf16 v218, v13, s62, 0
    v_dot2_f32_bf16 v219, v13, v13, 0
    v_dot2_f32_bf16 v220, v14, s62, 0
    v_dot2_f32_bf16 v221, v14, v14, 0
    v_dot2_f32_bf16 v222, v15, s62, 0
    v_dot2_f32_bf16 v223, v15, v15, 0
    s_nop 2
    v_permlane32_swap_b32 v208, v209
    v_permlane32_swap_b32 v210, v211
    v_permlane32_swap_b32 v212, v213
    v_permlane32_swap_b32 v214, v215
    v_permlane32_swap_b32 v216, v217
    v_permlane32_swap_b32 v218, v219
    v_permlane32_swap_b32 v220, v221
    v_permlane32_swap_b32 v222, v223
    v_add_f32 v208, v208, v209
    v_add_f32 v210, v210, v211
    v_add_f32 v212, v212, v213
    v_add_f32 v214, v214, v215
    v_add_f32 v216, v216, v217
    v_add_f32 v218, v218, v219
    v_add_f32 v220, v220, v221
    v_add_f32 v222, v222, v223
    v_permlane16_swap_b32 v208, v210
    v_permlane16_swap_b32 v212, v214
    v_permlane16_swap_b32 v216, v218
    v_permlane16_swap_b32 v220, v222
    v_add_f32 v208, v208, v210
    v_add_f32 v212, v212, v214
    v_add_f32 v216, v216, v218
    v_add_f32 v220, v220, v222
    v_add_f32_dpp v208, v208, v208 row_ror:8 row_mask:0xf bank_mask:0xf
    v_add_f32_dpp v212, v212, v212 row_ror:8 row_mask:0xf bank_mask:0xf
    v_add_f32_dpp v216, v216, v216 row_ror:8 row_mask:0xf bank_mask:0xf
    v_add_f32_dpp v220, v220, v220 row_ror:8 row_mask:0xf bank_mask:0xf
    v_add_f32_dpp v208, v208, v208 row_ror:4 row_mask:0xf bank_mask:0xf
    v_add_f32_dpp v212, v212, v212 row_ror:4 row_mask:0xf bank_mask:0xf
    v_add_f32_dpp v216, v216, v216 row_ror:4 row_mask:0xf bank_mask:0xf
    v_add_f32_dpp v220, v220, v220 row_ror:4 row_mask:0xf bank_mask:0xf
    v_add_f32_dpp v208, v208, v208 row_ror:2 row_mask:0xf bank_mask:0xf
    v_add_f32_dpp v212, v212, v212 row_ror:2 row_mask:0xf bank_mask:0xf
    v_add_f32_dpp v216, v216, v216 row_ror:2 row_mask:0xf bank_mask:0xf
    v_add_f32_dpp v220, v220, v220 row_ror:2 row_mask:0xf bank_mask:0xf
    v_add_f32_dpp v208, v208, v208 row_ror:1 row_mask:0xf bank_mask:0xf
    v_add_f32_dpp v212, v212, v212 row_ror:1 row_mask:0xf bank_mask:0xf
    v_add_f32_dpp v216, v216, v216 row_ror:1 row_mask:0xf bank_mask:0xf
    v_add_f32_dpp v220, v220, v220 row_ror:1 row_mask:0xf bank_mask:0xf
    s_mov_b32 exec_lo, 0x00010001
    s_mov_b32 exec_hi, 0x00010001
    ds_write_b32 v243, v208 offset:46080
    ds_write_b32 v243, v212 offset:46144
    ds_write_b32 v243, v216 offset:46208
    ds_write_b32 v243, v220 offset:46272
    s_mov_b64 exec, -1
    s_mov_b32 s62, 0x3b124925
    s_mov_b32 s63, 0x3727c5ac
    s_waitcnt lgkmcnt(0)
    s_barrier
    ds_read_b128 v[208:211], v244 offset:46080
    ds_read_b128 v[212:215], v244 offset:46096
    s_waitcnt lgkmcnt(0)
    v_add_f32 v208, v208, v209
    v_add_f32 v212, v212, v213
    v_add_f32 v210, v210, v211
    v_add_f32 v214, v214, v215
    v_add_f32 v208, v208, v210
    v_add_f32 v212, v212, v214
    v_mul_f32 v208, s62, v208
    v_mul_f32 v212, s62, v212
    v_fma_f32 v212, -v208, v208, v212
    v_max_f32 v212, 0, v212
    v_add_f32 v213, s63, v212
    v_rsq_f32 v213, v213
    s_nop 0
    v_readlane_b32 s64, v208, 0
    v_readlane_b32 s65, v213, 0
    v_readlane_b32 s66, v208, 1
    v_readlane_b32 s67, v213, 1
    v_readlane_b32 s68, v208, 2
    v_readlane_b32 s69, v213, 2
    v_readlane_b32 s70, v208, 3
    v_readlane_b32 s71, v213, 3
    v_readlane_b32 s72, v208, 4
    v_readlane_b32 s73, v213, 4
    v_readlane_b32 s74, v208, 5
    v_readlane_b32 s75, v213, 5
    v_readlane_b32 s76, v208, 6
    v_readlane_b32 s77, v213, 6
    v_readlane_b32 s78, v208, 7
    v_readlane_b32 s79, v213, 7
    v_lshlrev_b32 v208, 16, v8
    v_and_b32 v209, 0xffff0000, v8
    v_lshlrev_b32 v210, 16, v9
    v_and_b32 v211, 0xffff0000, v9
    v_lshlrev_b32 v212, 16, v10
    v_and_b32 v213, 0xffff0000, v10
    v_lshlrev_b32 v214, 16, v11
    v_and_b32 v215, 0xffff0000, v11
    v_lshlrev_b32 v216, 16, v12
    v_and_b32 v217, 0xffff0000, v12
    v_lshlrev_b32 v218, 16, v13
    v_and_b32 v219, 0xffff0000, v13
    v_lshlrev_b32 v220, 16, v14
    v_and_b32 v221, 0xffff0000, v14
    v_lshlrev_b32 v222, 16, v15
    v_and_b32 v223, 0xffff0000, v15
    v_pk_add_f32 v[192:193], v[208:209], s[64:65] op_sel_hi:[1,0] neg_lo:[0,1] neg_hi:[0,1]
    v_pk_add_f32 v[194:195], v[210:211], s[66:67] op_sel_hi:[1,0] neg_lo:[0,1] neg_hi:[0,1]
    v_pk_add_f32 v[196:197], v[212:213], s[68:69] op_sel_hi:[1,0] neg_lo:[0,1] neg_hi:[0,1]
    v_pk_add_f32 v[198:199], v[214:215], s[70:71] op_sel_hi:[1,0] neg_lo:[0,1] neg_hi:[0,1]
    v_pk_add_f32 v[200:201], v[216:217], s[72:73] op_sel_hi:[1,0] neg_lo:[0,1] neg_hi:[0,1]
    v_pk_add_f32 v[202:203], v[218:219], s[74:75] op_sel_hi:[1,0] neg_lo:[0,1] neg_hi:[0,1]
    v_pk_add_f32 v[204:205], v[220:221], s[76:77] op_sel_hi:[1,0] neg_lo:[0,1] neg_hi:[0,1]
    v_pk_add_f32 v[206:207], v[222:223], s[78:79] op_sel_hi:[1,0] neg_lo:[0,1] neg_hi:[0,1]
    v_pk_mul_f32 v[192:193], v[192:193], s[64:65] op_sel:[0,1] op_sel_hi:[1,1]
    v_pk_mul_f32 v[194:195], v[194:195], s[66:67] op_sel:[0,1] op_sel_hi:[1,1]
    v_pk_mul_f32 v[196:197], v[196:197], s[68:69] op_sel:[0,1] op_sel_hi:[1,1]
    v_pk_mul_f32 v[198:199], v[198:199], s[70:71] op_sel:[0,1] op_sel_hi:[1,1]
    v_pk_mul_f32 v[200:201], v[200:201], s[72:73] op_sel:[0,1] op_sel_hi:[1,1]
    v_pk_mul_f32 v[202:203], v[202:203], s[74:75] op_sel:[0,1] op_sel_hi:[1,1]
    v_pk_mul_f32 v[204:205], v[204:205], s[76:77] op_sel:[0,1] op_sel_hi:[1,1]
    v_pk_mul_f32 v[206:207], v[206:207], s[78:79] op_sel:[0,1] op_sel_hi:[1,1]
    s_mov_b32 s20, s38
    s_and_b32 s21, s39, 0xffff
    s_mov_b32 s22, 0x700000
    s_mov_b32 s23, 0x20000
    s_mov_b32 s24, s42
    s_and_b32 s25, s43, 0xffff
    s_mov_b32 s26, 0x700000
    s_mov_b32 s27, 0x20000
    s_sub_u32 s86, s54, 28
    v_and_b32 v2, 15, v0
    v_bfe_u32 v3, v0, 4, 2
    s_mul_i32 s62, s86, 9
    s_add_u32 s62, s62, 4
    s_lshl_b32 s62, s62, 4
    s_lshl_b32 s63, s52, 9
    s_add_u32 s62, s62, s63
    v_add_u32 v4, s62, v2
    v_mul_u32_u24 v4, 3584, v4
    s_mul_i32 s62, s53, 3
    s_min_u32 s81, s53, 4
    s_add_u32 s62, s62, s81
    v_add_u32 v5, s62, v3
    v_lshl_add_u32 v5, v5, 7, v4
    buffer_load_dword v246, v5, s[20:23], 0 offen
    s_waitcnt vmcnt(0)
    s_mul_i32 s62, s52, 448
    s_lshl_b32 s63, s86, 4
    s_add_u32 s62, s62, s63
    v_add_u32 v4, s62, v2
    v_lshlrev_b32 v4, 12, v4
    s_lshl_b32 s62, s53, 2
    v_add_u32 v5, s62, v3
    v_lshl_add_u32 v61, v5, 7, v4
    s_mov_b32 s82, 0
    buffer_load_dword v246, v61, s[24:27], s82 offen
    s_waitcnt vmcnt(0)
    s_mov_b32 s82, 262144
    buffer_load_dword v246, v61, s[24:27], s82 offen
    s_waitcnt vmcnt(0)
    v_lshlrev_b32 v58, 7, v0
    s_mov_b32 s80, 0
CB_13:
    buffer_load_dword v59, v58, s[16:19], 0 offen offset:8 sc1
    s_waitcnt vmcnt(0)
CB_13_chk:
    v_cmp_le_i32 vcc, 0, v58
    v_mov_b32 v60, s3
    s_nop 0
    v_cndmask_b32 v59, v60, v59, vcc
    v_cmp_ne_u32 vcc, s3, v59
    s_cbranch_vccz CB_13_ok
    s_add_u32 s80, s80, 1
    s_cmp_gt_u32 s80, 40000
    s_cbranch_scc1 CB_13_ok
    s_sleep 16
    s_branch CB_13
CB_13_ok:
    s_mov_b32 s80, 0
PY_14:
    s_mov_b32 s81, 0x300000
    buffer_load_dwordx4 v[48:51], v36, s[16:19], s81 offen sc1
    buffer_load_dwordx4 v[52:55], v241, s[16:19], s81 offen sc1
    s_waitcnt vmcnt(0)
PY_14_chk:
    v_max3_u32 v56, v48, v49, v50
    v_max3_u32 v57, v51, v52, v53
    v_max3_u32 v56, v56, v54, v55
    v_max_u32 v56, v56, v57
    v_cmp_eq_u32 vcc, -1, v56
    s_cbranch_vccz PY_14_ok
    s_add_u32 s80, s80, 1
    s_cmp_gt_u32 s80, 40000
    s_cbranch_scc1 PY_14_ok
    s_sleep 2
    s_branch PY_14
PY_14_ok:
    s_mov_b32 vcc_lo, 0x55555555
    s_mov_b32 vcc_hi, 0x55555555
    v_cndmask_b32_dpp v40, v52, v48, vcc quad_perm:[1,0,3,2] row_mask:0xf bank_mask:0xf
    v_cndmask_b32_dpp v41, v53, v49, vcc quad_perm:[1,0,3,2] row_mask:0xf bank_mask:0xf
    v_cndmask_b32_dpp v42, v54, v50, vcc quad_perm:[1,0,3,2] row_mask:0xf bank_mask:0xf
    v_cndmask_b32_dpp v43, v55, v51, vcc quad_perm:[1,0,3,2] row_mask:0xf bank_mask:0xf
    s_mov_b32 vcc_lo, 0xaaaaaaaa
    s_mov_b32 vcc_hi, 0xaaaaaaaa
    v_cndmask_b32_dpp v44, v48, v52, vcc quad_perm:[1,0,3,2] row_mask:0xf bank_mask:0xf
    v_cndmask_b32_dpp v45, v49, v53, vcc quad_perm:[1,0,3,2] row_mask:0xf bank_mask:0xf
    v_cndmask_b32_dpp v46, v50, v54, vcc quad_perm:[1,0,3,2] row_mask:0xf bank_mask:0xf
    v_cndmask_b32_dpp v47, v51, v55, vcc quad_perm:[1,0,3,2] row_mask:0xf bank_mask:0xf
    v_lshlrev_b32 v224, 16, v40
    v_and_b32 v226, 0xffff0000, v40
    v_lshlrev_b32 v228, 16, v41
    v_and_b32 v230, 0xffff0000, v41
    v_lshlrev_b32 v232, 16, v42
    v_and_b32 v234, 0xffff0000, v42
    v_lshlrev_b32 v236, 16, v43
    v_and_b32 v238, 0xffff0000, v43
    v_lshlrev_b32 v225, 16, v44
    v_and_b32 v227, 0xffff0000, v44
    v_lshlrev_b32 v229, 16, v45
    v_and_b32 v231, 0xffff0000, v45
    v_lshlrev_b32 v233, 16, v46
    v_and_b32 v235, 0xffff0000, v46
    v_lshlrev_b32 v237, 16, v47
    v_and_b32 v239, 0xffff0000, v47
    v_pk_fma_f32 v[208:209], v[192:193], v[224:225], v[208:209]
    v_pk_fma_f32 v[210:211], v[194:195], v[226:227], v[210:211]
    v_pk_fma_f32 v[212:213], v[196:197], v[228:229], v[212:213]
    v_pk_fma_f32 v[214:215], v[198:199], v[230:231], v[214:215]
    v_pk_fma_f32 v[216:217], v[200:201], v[232:233], v[216:217]
    v_pk_fma_f32 v[218:219], v[202:203], v[234:235], v[218:219]
    v_pk_fma_f32 v[220:221], v[204:205], v[236:237], v[220:221]
    v_pk_fma_f32 v[222:223], v[206:207], v[238:239], v[222:223]
    v_cvt_pk_bf16_f32 v8, v208, v209
    v_cvt_pk_bf16_f32 v9, v210, v211
    v_cvt_pk_bf16_f32 v10, v212, v213
    v_cvt_pk_bf16_f32 v11, v214, v215
    v_cvt_pk_bf16_f32 v12, v216, v217
    v_cvt_pk_bf16_f32 v13, v218, v219
    v_cvt_pk_bf16_f32 v14, v220, v221
    v_cvt_pk_bf16_f32 v15, v222, v223
    s_mov_b32 s62, 0x3f803f80
    v_dot2_f32_bf16 v224, v8, s62, 0
    v_dot2_f32_bf16 v225, v8, v8, 0
    v_dot2_f32_bf16 v226, v9, s62, 0
    v_dot2_f32_bf16 v227, v9, v9, 0
    v_dot2_f32_bf16 v228, v10, s62, 0
    v_dot2_f32_bf16 v229, v10, v10, 0
    v_dot2_f32_bf16 v230, v11, s62, 0
    v_dot2_f32_bf16 v231, v11, v11, 0
    v_dot2_f32_bf16 v232, v12, s62, 0
    v_dot2_f32_bf16 v233, v12, v12, 0
    v_dot2_f32_bf16 v234, v13, s62, 0
    v_dot2_f32_bf16 v235, v13, v13, 0
    v_dot2_f32_bf16 v236, v14, s62, 0
    v_dot2_f32_bf16 v237, v14, v14, 0
    v_dot2_f32_bf16 v238, v15, s62, 0
    v_dot2_f32_bf16 v239, v15, v15, 0
    s_nop 1
    v_permlane32_swap_b32 v224, v225
    v_permlane32_swap_b32 v226, v227
    v_permlane32_swap_b32 v228, v229
    v_permlane32_swap_b32 v230, v231
    v_permlane32_swap_b32 v232, v233
    v_permlane32_swap_b32 v234, v235
    v_permlane32_swap_b32 v236, v237
    v_permlane32_swap_b32 v238, v239
    v_add_f32 v224, v224, v225
    v_add_f32 v226, v226, v227
    v_add_f32 v228, v228, v229
    v_add_f32 v230, v230, v231
    v_add_f32 v232, v232, v233
    v_add_f32 v234, v234, v235
    v_add_f32 v236, v236, v237
    v_add_f32 v238, v238, v239
    v_permlane16_swap_b32 v224, v226
    v_permlane16_swap_b32 v228, v230
    v_permlane16_swap_b32 v232, v234
    v_permlane16_swap_b32 v236, v238
    v_add_f32 v224, v224, v226
    v_add_f32 v228, v228, v230
    v_add_f32 v232, v232, v234
    v_add_f32 v236, v236, v238
    v_add_f32_dpp v224, v224, v224 row_ror:8 row_mask:0xf bank_mask:0xf
    v_add_f32_dpp v228, v228, v228 row_ror:8 row_mask:0xf bank_mask:0xf
    v_add_f32_dpp v232, v232, v232 row_ror:8 row_mask:0xf bank_mask:0xf
    v_add_f32_dpp v236, v236, v236 row_ror:8 row_mask:0xf bank_mask:0xf
    v_add_f32_dpp v224, v224, v224 row_ror:4 row_mask:0xf bank_mask:0xf
    v_add_f32_dpp v228, v228, v228 row_ror:4 row_mask:0xf bank_mask:0xf
    v_add_f32_dpp v232, v232, v232 row_ror:4 row_mask:0xf bank_mask:0xf
    v_add_f32_dpp v236, v236, v236 row_ror:4 row_mask:0xf bank_mask:0xf
    v_add_f32_dpp v224, v224, v224 row_ror:2 row_mask:0xf bank_mask:0xf
    v_add_f32_dpp v228, v228, v228 row_ror:2 row_mask:0xf bank_mask:0xf
    v_add_f32_dpp v232, v232, v232 row_ror:2 row_mask:0xf bank_mask:0xf
    v_add_f32_dpp v236, v236, v236 row_ror:2 row_mask:0xf bank_mask:0xf
    v_add_f32_dpp v224, v224, v224 row_ror:1 row_mask:0xf bank_mask:0xf
    v_add_f32_dpp v228, v228, v228 row_ror:1 row_mask:0xf bank_mask:0xf
    v_add_f32_dpp v232, v232, v232 row_ror:1 row_mask:0xf bank_mask:0xf
    v_add_f32_dpp v236, v236, v236 row_ror:1 row_mask:0xf bank_mask:0xf
    s_mov_b32 exec_lo, 0x00010001
    s_mov_b32 exec_hi, 0x00010001
    ds_write_b32 v243, v224 offset:46336
    ds_write_b32 v243, v228 offset:46400
    ds_write_b32 v243, v232 offset:46464
    ds_write_b32 v243, v236 offset:46528
    s_mov_b64 exec, -1
    s_mov_b32 s82, 0x500000
    s_mov_b32 s83, 0x501180
    buffer_store_dword v8, v37, s[16:19], s82 offen offset:0 sc1
    buffer_store_dword v9, v37, s[16:19], s82 offen offset:896 sc1
    buffer_store_dword v10, v37, s[16:19], s82 offen offset:1792 sc1
    buffer_store_dword v11, v37, s[16:19], s82 offen offset:2688 sc1
    buffer_store_dword v12, v37, s[16:19], s82 offen offset:3584 sc1
    buffer_store_dword v13, v37, s[16:19], s83 offen offset:0 sc1
    buffer_store_dword v14, v37, s[16:19], s83 offen offset:896 sc1
    buffer_store_dword v15, v37, s[16:19], s83 offen offset:1792 sc1
    v_lshlrev_b32 v208, 16, v8
    v_and_b32 v209, 0xffff0000, v8
    v_lshlrev_b32 v210, 16, v9
    v_and_b32 v211, 0xffff0000, v9
    v_lshlrev_b32 v212, 16, v10
    v_and_b32 v213, 0xffff0000, v10
    v_lshlrev_b32 v214, 16, v11
    v_and_b32 v215, 0xffff0000, v11
    v_lshlrev_b32 v216, 16, v12
    v_and_b32 v217, 0xffff0000, v12
    v_lshlrev_b32 v218, 16, v13
    v_and_b32 v219, 0xffff0000, v13
    v_lshlrev_b32 v220, 16, v14
    v_and_b32 v221, 0xffff0000, v14
    v_lshlrev_b32 v222, 16, v15
    v_and_b32 v223, 0xffff0000, v15
    s_mov_b32 s62, 0x3b124925
    s_mov_b32 s63, 0x3727c5ac
    s_waitcnt lgkmcnt(0)
    s_barrier
    ds_read_b128 v[224:227], v244 offset:46336
    ds_read_b128 v[228:231], v244 offset:46352
    s_waitcnt lgkmcnt(0)
    v_add_f32 v224, v224, v225
    v_add_f32 v228, v228, v229
    v_add_f32 v226, v226, v227
    v_add_f32 v230, v230, v231
    v_add_f32 v224, v224, v226
    v_add_f32 v228, v228, v230
    v_mul_f32 v224, s62, v224
    v_mul_f32 v228, s62, v228
    v_fma_f32 v228, -v224, v224, v228
    v_max_f32 v228, 0, v228
    v_add_f32 v229, s63, v228
    v_rsq_f32 v229, v229
    s_nop 0
    v_mul_f32 v230, v229, v229
    v_mul_f32 v230, v230, v228
    v_add_f32 v230, s63, v230
    v_rsq_f32 v230, v230
    s_nop 0
    v_mul_f32 v229, v229, v230
    v_readlane_b32 s64, v224, 0
    v_readlane_b32 s65, v229, 0
    v_readlane_b32 s66, v224, 1
    v_readlane_b32 s67, v229, 1
    v_readlane_b32 s68, v224, 2
    v_readlane_b32 s69, v229, 2
    v_readlane_b32 s70, v224, 3
    v_readlane_b32 s71, v229, 3
    v_readlane_b32 s72, v224, 4
    v_readlane_b32 s73, v229, 4
    v_readlane_b32 s74, v224, 5
    v_readlane_b32 s75, v229, 5
    v_readlane_b32 s76, v224, 6
    v_readlane_b32 s77, v229, 6
    v_readlane_b32 s78, v224, 7
    v_readlane_b32 s79, v229, 7
    v_pk_add_f32 v[208:209], v[208:209], s[64:65] op_sel_hi:[1,0] neg_lo:[0,1] neg_hi:[0,1]
    v_pk_add_f32 v[210:211], v[210:211], s[66:67] op_sel_hi:[1,0] neg_lo:[0,1] neg_hi:[0,1]
    v_pk_add_f32 v[212:213], v[212:213], s[68:69] op_sel_hi:[1,0] neg_lo:[0,1] neg_hi:[0,1]
    v_pk_add_f32 v[214:215], v[214:215], s[70:71] op_sel_hi:[1,0] neg_lo:[0,1] neg_hi:[0,1]
    v_pk_add_f32 v[216:217], v[216:217], s[72:73] op_sel_hi:[1,0] neg_lo:[0,1] neg_hi:[0,1]
    v_pk_add_f32 v[218:219], v[218:219], s[74:75] op_sel_hi:[1,0] neg_lo:[0,1] neg_hi:[0,1]
    v_pk_add_f32 v[220:221], v[220:221], s[76:77] op_sel_hi:[1,0] neg_lo:[0,1] neg_hi:[0,1]
    v_pk_add_f32 v[222:223], v[222:223], s[78:79] op_sel_hi:[1,0] neg_lo:[0,1] neg_hi:[0,1]
    v_pk_mul_f32 v[208:209], v[208:209], s[64:65] op_sel:[0,1] op_sel_hi:[1,1]
    v_pk_mul_f32 v[210:211], v[210:211], s[66:67] op_sel:[0,1] op_sel_hi:[1,1]
    v_pk_mul_f32 v[212:213], v[212:213], s[68:69] op_sel:[0,1] op_sel_hi:[1,1]
    v_pk_mul_f32 v[214:215], v[214:215], s[70:71] op_sel:[0,1] op_sel_hi:[1,1]
    v_pk_mul_f32 v[216:217], v[216:217], s[72:73] op_sel:[0,1] op_sel_hi:[1,1]
    v_pk_mul_f32 v[218:219], v[218:219], s[74:75] op_sel:[0,1] op_sel_hi:[1,1]
    v_pk_mul_f32 v[220:221], v[220:221], s[76:77] op_sel:[0,1] op_sel_hi:[1,1]
    v_pk_mul_f32 v[222:223], v[222:223], s[78:79] op_sel:[0,1] op_sel_hi:[1,1]
    v_cvt_pk_bf16_f32 v48, v208, v210
    v_cvt_pk_bf16_f32 v49, v212, v214
    v_cvt_pk_bf16_f32 v50, v216, v218
    v_cvt_pk_bf16_f32 v51, v220, v222
    v_cvt_pk_bf16_f32 v52, v209, v211
    v_cvt_pk_bf16_f32 v53, v213, v215
    v_cvt_pk_bf16_f32 v54, v217, v219
    v_cvt_pk_bf16_f32 v55, v221, v223
    s_mov_b32 vcc_lo, 0x55555555
    s_mov_b32 vcc_hi, 0x55555555
    v_cndmask_b32_dpp v40, v52, v48, vcc quad_perm:[1,0,3,2] row_mask:0xf bank_mask:0xf
    v_cndmask_b32_dpp v41, v53, v49, vcc quad_perm:[1,0,3,2] row_mask:0xf bank_mask:0xf
    v_cndmask_b32_dpp v42, v54, v50, vcc quad_perm:[1,0,3,2] row_mask:0xf bank_mask:0xf
    v_cndmask_b32_dpp v43, v55, v51, vcc quad_perm:[1,0,3,2] row_mask:0xf bank_mask:0xf
    s_mov_b32 vcc_lo, 0xaaaaaaaa
    s_mov_b32 vcc_hi, 0xaaaaaaaa
    v_cndmask_b32_dpp v44, v48, v52, vcc quad_perm:[1,0,3,2] row_mask:0xf bank_mask:0xf
    v_cndmask_b32_dpp v45, v49, v53, vcc quad_perm:[1,0,3,2] row_mask:0xf bank_mask:0xf
    v_cndmask_b32_dpp v46, v50, v54, vcc quad_perm:[1,0,3,2] row_mask:0xf bank_mask:0xf
    v_cndmask_b32_dpp v47, v51, v55, vcc quad_perm:[1,0,3,2] row_mask:0xf bank_mask:0xf
    s_mov_b32 s82, 0x700000
    buffer_store_dwordx4 v[40:43], v38, s[16:19], s82 offen sc1
    buffer_store_dwordx4 v[44:47], v242, s[16:19], s82 offen sc1
    s_waitcnt vmcnt(0)
    s_barrier
    s_cmp_lg_u32 s52, 0
    s_cbranch_scc1 PUB_15
    s_lshl_b32 s62, s2, 7
    v_mov_b32 v2, s3
    s_mov_b64 exec, 1
    buffer_store_dword v2, off, s[16:19], s62 offset:4 sc1
    s_mov_b64 exec, -1
PUB_15:
    s_mov_b32 s82, 524288
    buffer_load_dword v246, v61, s[24:27], s82 offen
    s_waitcnt vmcnt(0)
    s_mov_b32 s82, 786432
    buffer_load_dword v246, v61, s[24:27], s82 offen
    s_waitcnt vmcnt(0)
    s_mov_b32 s82, 1048576
    buffer_load_dword v246, v61, s[24:27], s82 offen
    s_waitcnt vmcnt(0)
    s_mov_b32 s82, 1310720
    buffer_load_dword v246, v61, s[24:27], s82 offen
    s_waitcnt vmcnt(0)
    s_mov_b32 s82, 1572864
    buffer_load_dword v246, v61, s[24:27], s82 offen
    s_waitcnt vmcnt(0)
FIN:
END:
    s_endpgm
L_CODE_END:
    s_endpgm
.section .rodata,"a"
.p2align 6
.amdhsa_kernel sequential_preLN__ssm_conv_h3__mixer_token_mlp__prompt_kernel
  .amdhsa_next_free_vgpr 512
  .amdhsa_next_free_sgpr 102
  .amdhsa_accum_offset 256
  .amdhsa_group_segment_fixed_size 0
  .amdhsa_kernarg_size 112
  .amdhsa_user_sgpr_count 2
  .amdhsa_user_sgpr_kernarg_segment_ptr 1
  .amdhsa_system_sgpr_workgroup_id_x 1
  .amdhsa_float_denorm_mode_32 3
.end_amdhsa_kernel
```
